```python
import torch

def _softmax(x, axis=-1):
    return torch.softmax(x, dim=axis)
def _gelu(x):
    return torch.nn.functional.gelu(x, approximate="tanh")
def _silu(x):
    return torch.nn.functional.silu(x)
def _sigmoid(x):
    return torch.sigmoid(x)
def _layernorm(x, axis=-1, eps=1e-5):
    m = x.mean(dim=axis, keepdim=True)
    v = x.var(dim=axis, keepdim=True, unbiased=False)
    return (x - m) / torch.sqrt(v + eps)
def _scatter_add(tgt, idx, src, axis=0):
    return tgt.clone().index_add_(axis, idx, src)
def _segment_sum(src, seg, n):
    out = torch.zeros((n,) + src.shape[1:], dtype=src.dtype)
    return out.index_add_(0, seg, src)
def _pad(x, pw):
    flat = tuple(v for pair in reversed(pw) for v in pair)
    return torch.nn.functional.pad(x, flat)

kernel_name = 'parallel_sum__gqa_block_cached__swiglu_ffn__decode'

def setup_inputs():

    _w = (lambda a: (lambda t: t.to(torch.bfloat16) if t.is_floating_point() else t)(torch.as_tensor(a)))
    def _A_setup():
        B, Sq, D = 2, 1, 576
        Hq, Hkv, Sk, Dh = 32, 16, 4096, 128
        assert Hq % Hkv == 0, (Hq, Hkv)
        return {
            "x": _w((lambda *s: torch.randn(*s, dtype=torch.bfloat16) * 0.05)(B, Sq, D)),
            "k_cache": _w((lambda *s: torch.randn(*s, dtype=torch.bfloat16) * 3.2)(B, Hkv, Sk, Dh)),
            "v_cache": _w((lambda *s: torch.randn(*s, dtype=torch.bfloat16) * 1.6)(B, Hkv, Sk, Dh)),
            "wq": _w((lambda *s: torch.randn(*s, dtype=torch.bfloat16) * 3.2)(D, Hq * Dh) * (D ** -0.5)),
            "wo": _w((lambda *s: torch.randn(*s, dtype=torch.bfloat16) * 1.6)(Hq * Dh, D) * ((Hq * Dh) ** -0.5)),
        }
    _A_in = _A_setup()

    def _B_setup():
        B, S, D, F = 2, 1, 576, 4608
        return {
            "x": _w((lambda *s: torch.randn(*s, dtype=torch.bfloat16) * 0.05)(B, S, D)),
            "w_gate": _w((lambda *s: torch.randn(*s, dtype=torch.bfloat16) * 0.05)(D, F)),
            "w_up": _w((lambda *s: torch.randn(*s, dtype=torch.bfloat16) * 0.05)(D, F)),
            "w_down": _w((lambda *s: torch.randn(*s, dtype=torch.bfloat16) * 0.05)(F, D)),
        }
    _B_in = _B_setup()

    return {
        "A_x": _A_in["x"],
        "A_k_cache": _A_in["k_cache"],
        "A_v_cache": _A_in["v_cache"],
        "A_wq": _A_in["wq"],
        "A_wo": _A_in["wo"],
        "B_x": _B_in["x"],
        "B_w_gate": _B_in["w_gate"],
        "B_w_up": _B_in["w_up"],
        "B_w_down": _B_in["w_down"],
    }

def reference(A_x, A_k_cache, A_v_cache, A_wq, A_wo, B_x, B_w_gate, B_w_up, B_w_down):
    def _A_ref(x, k_cache, v_cache, wq, wo):
        B, Sq, D = x.shape
        Hq, Dh = 32, 128
        Hkv = k_cache.shape[1]
        rep = Hq // Hkv
        q = (lambda x, *d: x.permute(*d))((x @ wq).reshape(B, Sq, Hq, Dh), 0, 2, 1, 3)
        k = (lambda x, n, axis: torch.repeat_interleave(x, n, dim=axis))(k_cache, rep, axis=1)
        v = (lambda x, n, axis: torch.repeat_interleave(x, n, dim=axis))(v_cache, rep, axis=1)
        scores = torch.einsum("bhqd,bhkd->bhqk", q, k) * (Dh ** -0.5)
        p = _softmax(scores, axis=-1)
        o = torch.einsum("bhqk,bhkd->bhqd", p, v)
        return (lambda x, *d: x.permute(*d))(o, 0, 2, 1, 3).reshape(B, Sq, Hq * Dh) @ wo

    def _B_ref(x, w_gate, w_up, w_down):
        g = _silu(x @ w_gate)
        u = x @ w_up
        return (g * u) @ w_down

    x = A_x
    xn = _layernorm(x, axis=-1)
    return x + _A_ref(xn, A_k_cache, A_v_cache, A_wq, A_wo) + _B_ref(xn, B_w_gate, B_w_up, B_w_down)
```

```asm
; @launch grid=(256,1,1) block=(512,1,1) lds=51200
.amdgcn_target "amdgcn-amd-amdhsa--gfx950"
.text
.globl parallel_sum__gqa_block_cached__swiglu_ffn__decode_kernel
.p2align 8
.type parallel_sum__gqa_block_cached__swiglu_ffn__decode_kernel,@function
parallel_sum__gqa_block_cached__swiglu_ffn__decode_kernel:
    s_cmp_ge_u32 s2, 256
    s_cbranch_scc1 L_end
    s_load_dwordx4 s[40:43], s[0:1], 0
    s_load_dwordx4 s[44:47], s[0:1], 16
    s_load_dwordx2 s[48:49], s[0:1], 32
    s_load_dwordx4 s[52:55], s[0:1], 48
    s_load_dwordx4 s[56:59], s[0:1], 64
    s_load_dwordx2 s[60:61], s[0:1], 88
    v_lshrrev_b32 v1, 6, v0
    v_and_b32 v0, 63, v0
    v_readfirstlane_b32 s3, v1
    v_mov_b32 v1, 0
    v_lshlrev_b32 v12, 2, v0
    s_cmp_lg_u32 s3, 0
    s_cbranch_scc1 L_noz
    s_mov_b64 exec, 0xffff
    ds_write_b32 v12, v1 offset:4608
    s_mov_b64 exec, -1
    s_waitcnt lgkmcnt(0)
L_noz:

    v_lshrrev_b32 v2, 4, v0
    v_and_b32 v3, 15, v0
    v_lshrrev_b32 v4, 3, v0
    v_and_b32 v5, 7, v0
    v_lshrrev_b32 v6, 5, v0
    v_mul_u32_u24 v6, 1152, v6
    v_and_b32 v7, 31, v0
    v_lshl_add_u32 v6, v7, 4, v6
    v_cmp_gt_u32 vcc, 8, v7
    v_add_u32 v7, 1024, v6
    v_mov_b32 v8, 0x7fff0000
    v_cndmask_b32 v7, v8, v7, vcc
    v_and_b32 v8, 1, v0
    v_mul_u32_u24 v8, 1152, v8
    s_mul_i32 s62, s3, 144
    v_add_u32 v8, s62, v8
    v_bfe_u32 v9, v0, 1, 1
    v_lshl_add_u32 v10, v2, 5, v8
    v_lshl_add_u32 v10, v9, 4, v10
    v_lshl_add_u32 v11, v2, 2, v8
    v_lshl_add_u32 v11, v9, 1, v11
    s_and_b32 s69, s2, 7
    s_lshr_b32 s39, s2, 3
    s_lshr_b32 s64, s69, 1
    s_mul_i32 s64, s64, 52
    s_and_b32 s62, s69, 1
    s_mul_i32 s62, s62, 24
    s_add_u32 s64, s64, s62
    s_add_u32 s64, s64, s39
    s_mov_b32 s65, 8192
    s_mov_b32 s66, s64
    s_mov_b32 s67, 4096
    s_mov_b32 s68, 16384
    s_waitcnt lgkmcnt(0)
    s_load_dword s63, s[60:61], 0
    s_mov_b32 s16, s46
    s_mov_b32 s17, s47
    s_mov_b32 s18, 4718592
    s_mov_b32 s19, 0x20000
    s_mov_b32 s100, 1
    s_and_b32 s62, s69, 1
    s_lshl_b32 s62, s62, 2
    s_add_u32 s62, s62, 24
    s_cmp_lt_u32 s39, s62
    s_cbranch_scc1 L_roleE_own
    s_sub_u32 s62, s39, s62
    s_lshr_b32 s64, s69, 1
    s_bitcmp1_b32 s69, 0
    s_cbranch_scc0 L_hev
    s_lshl_b32 s64, s64, 2
    s_add_u32 s64, s64, s62
    s_branch L_hdone
L_hev:
    s_mul_i32 s64, s64, 3
    s_add_u32 s64, s64, s62
    s_add_u32 s64, s64, 16
    s_cmp_lt_u32 s62, 3
    s_cselect_b32 s64, s64, 99
L_hdone:
    s_cmp_ge_u32 s64, 26
    s_cbranch_scc1 L_roleE_none
    s_lshl_b32 s64, s64, 3
    s_add_u32 s64, s64, 3
    s_mov_b32 s66, s64
    s_mov_b32 s100, 3
    s_branch L_roleE_sel
L_roleE_own:
    s_and_b32 s62, s64, 7
    s_cmp_eq_u32 s62, 3
    s_cselect_b32 s100, 2, 1
L_roleE_sel:
    s_cmp_lt_u32 s64, 64
    s_cbranch_scc1 L_roleE_mask
    s_mov_b32 s16, s52
    s_mov_b32 s17, s53
    s_mov_b32 s18, 5308416
    s_mov_b32 s65, 9216
    s_sub_u32 s66, s64, 64
    s_mov_b32 s67, 36864
    s_mov_b32 s68, 18432
    s_cmp_lt_u32 s64, 136
    s_cbranch_scc1 L_roleE_mask
    s_mov_b32 s16, s54
    s_mov_b32 s17, s55
    s_sub_u32 s66, s64, 136
    s_mov_b32 s67, 73728
L_roleE_mask:
    s_cmp_eq_u32 s100, 1
    s_cbranch_scc1 L_roleE_done
    s_lshr_b32 s62, s3, 2
    s_add_u32 s62, s62, 2
    s_cmp_eq_u32 s62, s100
    s_cbranch_scc1 L_roleE_done
    s_mov_b32 s18, 0
    s_branch L_roleE_done
L_roleE_none:
    s_mov_b32 s100, 0
    s_mov_b32 s18, 0
    s_mov_b32 s66, 0
L_roleE_done:
    s_lshr_b32 s97, s64, 3
    s_mov_b32 s101, 0
    s_mov_b32 s4, s40
    s_mov_b32 s5, s41
    s_mov_b32 s6, 2304
    s_mov_b32 s7, 0x20000
    buffer_load_dwordx4 v[80:83], v6, s[4:7], 0 offen
    buffer_load_dwordx4 v[84:87], v6, s[4:7], 0 offen offset:512
    buffer_load_dwordx4 v[88:91], v7, s[4:7], 0 offen
    s_barrier
    s_mul_i32 s62, s3, 72
    v_lshl_add_u32 v12, v4, 3, s62
    v_mul_lo_u32 v12, v12, s65
    s_lshl_b32 s69, s66, 7
    v_lshlrev_b32 v14, 4, v5
    v_add3_u32 v12, v12, v14, s69
    s_add_u32 s62, s62, 64
    v_add_u32 v13, s62, v4
    v_mul_lo_u32 v13, v13, s65
    v_add3_u32 v13, v13, v14, s69
    s_mov_b32 s62, 0
    v_mov_b32 v1, v12
    s_mov_b32 s8, s42
    s_mov_b32 s9, s43
    s_mov_b32 s10, 0x2000000
    s_mov_b32 s11, 0x20000
    s_and_b32 s46, s2, 7
    s_lshl_b32 s46, s46, 4
    s_bfe_u32 s62, s2, 0x40003
    s_add_u32 s46, s46, s62
    s_lshr_b32 s62, s2, 7
    s_lshl_b32 s62, s62, 7
    s_add_u32 s46, s46, s62
    s_lshl_b32 s47, s46, 17
    s_lshl_b32 s46, s3, 10
    s_add_u32 s47, s47, s46
    v_lshlrev_b32 v14, 4, v0
    s_mul_i32 s62, s65, 0
    buffer_load_dwordx4 v[144:147], v1, s[16:19], s62 offen nt
    s_mul_i32 s62, s65, 1
    buffer_load_dwordx4 v[148:151], v1, s[16:19], s62 offen nt
    s_mul_i32 s62, s65, 2
    buffer_load_dwordx4 v[152:155], v1, s[16:19], s62 offen nt
    s_mul_i32 s62, s65, 3
    buffer_load_dwordx4 v[156:159], v1, s[16:19], s62 offen nt
    s_mul_i32 s62, s65, 4
    buffer_load_dwordx4 v[160:163], v1, s[16:19], s62 offen nt
    s_mov_b32 s12, s44
    s_mov_b32 s13, s45
    s_mov_b32 s14, 0x2000000
    s_mov_b32 s15, 0x20000
    v_lshlrev_b32 v15, 4, v0
    s_mov_b32 s28, s60
    s_mov_b32 s29, s61
    s_mov_b32 s30, 2097152
    s_mov_b32 s31, 0x20000
    s_mov_b32 s32, s58
    s_mov_b32 s33, s59
    s_mov_b32 s34, 2304
    s_mov_b32 s35, 0x20000
    s_mov_b32 s37, 0x05040100
    s_mov_b32 s38, 0x07060302
    s_mov_b32 s20, s48
    s_mov_b32 s21, s49
    s_mov_b32 s22, 4718592
    s_mov_b32 s23, 0x20000
    s_mov_b32 s24, s48
    s_mov_b32 s25, s49
    s_mov_b32 s26, 0
    s_mov_b32 s27, 0x20000
    s_and_b32 s45, s2, 7
    s_lshr_b32 s46, s2, 3
    s_mov_b32 s40, 0
    s_mov_b32 s39, 4
    s_mul_i32 s44, s45, 18
    s_add_u32 s44, s44, s46
    s_cmp_lt_u32 s46, 18
    s_cbranch_scc1 L_roleL_a
    s_mul_i32 s44, s45, 14
    s_add_u32 s44, s44, s46
    s_sub_u32 s44, s44, 18
    s_cmp_lt_u32 s44, 108
    s_cbranch_scc1 L_roleL_dn
    s_mov_b32 s40, 2
    s_mov_b32 s22, 0
    s_mov_b32 s44, 0
    s_branch L_roleL_a
L_roleL_dn:
    s_mov_b32 s40, 1
    s_mov_b32 s39, 6
    s_mov_b32 s20, s56
    s_mov_b32 s21, s57
    s_mov_b32 s22, 5308416
    s_mov_b32 s24, s56
    s_mov_b32 s25, s57
    s_mov_b32 s26, 5308416
L_roleL_a:
    s_mul_hi_u32 s45, s44, 0x1C71C71D
    s_mul_i32 s46, s45, 9
    s_sub_u32 s41, s44, s46
    s_cmp_eq_u32 s40, 1
    s_cselect_b32 s46, 16, 0
    s_add_u32 s42, s45, s46
    s_cmp_eq_u32 s40, 1
    s_movk_i32 s46, 256
    s_cselect_b32 s46, 384, s46
    s_mul_i32 s43, s45, s46
    s_and_b32 s46, s2, 7
    s_lshl_b32 s46, s46, 4
    s_bfe_u32 s62, s2, 0x40003
    s_add_u32 s46, s46, s62
    s_lshr_b32 s62, s2, 7
    s_lshl_b32 s62, s62, 7
    s_add_u32 s46, s46, s62
    s_waitcnt vmcnt(5)
    s_mul_i32 s62, s65, 5
    buffer_load_dwordx4 v[164:167], v1, s[16:19], s62 offen nt
    s_mul_i32 s62, s65, 6
    buffer_load_dwordx4 v[240:243], v1, s[16:19], s62 offen nt
    s_mul_i32 s62, s65, 7
    buffer_load_dwordx4 v[244:247], v1, s[16:19], s62 offen nt
    buffer_load_dwordx4 v[248:251], v13, s[16:19], 0 offen nt
    ds_write_b128 v6, v[80:83] offset:5120
    ds_write_b128 v6, v[84:87] offset:5632
    v_and_b32 v8, 31, v0
    v_cmp_gt_u32 vcc, 8, v8
    s_nop 0
    s_mov_b64 exec, vcc
    ds_write_b128 v6, v[88:91] offset:6144
    s_mov_b64 exec, -1
    s_waitcnt lgkmcnt(0)
    ds_read_b128 v[92:95], v10 offset:5120
    ds_read_u16 v96, v11 offset:5248
    v_lshlrev_b32 v168, 16, v80
    v_and_b32 v169, 0xffff0000, v80
    v_lshlrev_b32 v170, 16, v81
    v_and_b32 v171, 0xffff0000, v81
    v_lshlrev_b32 v172, 16, v82
    v_and_b32 v173, 0xffff0000, v82
    v_lshlrev_b32 v174, 16, v83
    v_and_b32 v175, 0xffff0000, v83
    v_lshlrev_b32 v176, 16, v84
    v_and_b32 v177, 0xffff0000, v84
    v_lshlrev_b32 v178, 16, v85
    v_and_b32 v179, 0xffff0000, v85
    v_lshlrev_b32 v180, 16, v86
    v_and_b32 v181, 0xffff0000, v86
    v_lshlrev_b32 v182, 16, v87
    v_and_b32 v183, 0xffff0000, v87
    v_lshlrev_b32 v184, 16, v88
    v_and_b32 v185, 0xffff0000, v88
    v_lshlrev_b32 v186, 16, v89
    v_and_b32 v187, 0xffff0000, v89
    v_lshlrev_b32 v188, 16, v90
    v_and_b32 v189, 0xffff0000, v90
    v_lshlrev_b32 v190, 16, v91
    v_and_b32 v191, 0xffff0000, v91
    v_add_f32 v200, v168, v169
    v_add_f32 v201, v170, v171
    v_add_f32 v200, v200, v172
    v_add_f32 v201, v201, v173
    v_add_f32 v200, v200, v174
    v_add_f32 v201, v201, v175
    v_add_f32 v200, v200, v176
    v_add_f32 v201, v201, v177
    v_add_f32 v200, v200, v178
    v_add_f32 v201, v201, v179
    v_add_f32 v200, v200, v180
    v_add_f32 v201, v201, v181
    v_add_f32 v200, v200, v182
    v_add_f32 v201, v201, v183
    v_add_f32 v200, v200, v184
    v_add_f32 v201, v201, v185
    v_add_f32 v200, v200, v186
    v_add_f32 v201, v201, v187
    v_add_f32 v200, v200, v188
    v_add_f32 v201, v201, v189
    v_add_f32 v200, v200, v190
    v_add_f32 v201, v201, v191
    v_add_f32 v200, v200, v201
    s_nop 1
    v_add_f32_dpp v200, v200, v200 row_ror:8 row_mask:0xf bank_mask:0xf
    s_nop 1
    v_add_f32_dpp v200, v200, v200 row_ror:4 row_mask:0xf bank_mask:0xf
    s_nop 1
    v_add_f32_dpp v200, v200, v200 row_ror:2 row_mask:0xf bank_mask:0xf
    s_nop 1
    v_add_f32_dpp v200, v200, v200 row_ror:1 row_mask:0xf bank_mask:0xf
    v_mov_b32 v201, v200
    s_nop 1
    v_permlane16_swap_b32 v200, v201
    v_add_f32 v200, v200, v201
    v_mul_f32 v200, 0x3ae38e39, v200
    v_and_b32 v202, 31, v0
    v_cmp_gt_u32 vcc, 8, v202
    v_sub_f32 v168, v168, v200
    v_sub_f32 v169, v169, v200
    v_sub_f32 v170, v170, v200
    v_sub_f32 v171, v171, v200
    v_sub_f32 v172, v172, v200
    v_sub_f32 v173, v173, v200
    v_sub_f32 v174, v174, v200
    v_sub_f32 v175, v175, v200
    v_sub_f32 v176, v176, v200
    v_sub_f32 v177, v177, v200
    v_sub_f32 v178, v178, v200
    v_sub_f32 v179, v179, v200
    v_sub_f32 v180, v180, v200
    v_sub_f32 v181, v181, v200
    v_sub_f32 v182, v182, v200
    v_sub_f32 v183, v183, v200
    v_sub_f32 v184, v184, v200
    v_sub_f32 v185, v185, v200
    v_sub_f32 v186, v186, v200
    v_sub_f32 v187, v187, v200
    v_sub_f32 v188, v188, v200
    v_sub_f32 v189, v189, v200
    v_sub_f32 v190, v190, v200
    v_sub_f32 v191, v191, v200
    v_cndmask_b32 v184, 0, v184, vcc
    v_cndmask_b32 v185, 0, v185, vcc
    v_cndmask_b32 v186, 0, v186, vcc
    v_cndmask_b32 v187, 0, v187, vcc
    v_cndmask_b32 v188, 0, v188, vcc
    v_cndmask_b32 v189, 0, v189, vcc
    v_cndmask_b32 v190, 0, v190, vcc
    v_cndmask_b32 v191, 0, v191, vcc
    v_mul_f32 v202, v168, v168
    v_mul_f32 v203, v169, v169
    v_fmac_f32 v202, v170, v170
    v_fmac_f32 v203, v171, v171
    v_fmac_f32 v202, v172, v172
    v_fmac_f32 v203, v173, v173
    v_fmac_f32 v202, v174, v174
    v_fmac_f32 v203, v175, v175
    v_fmac_f32 v202, v176, v176
    v_fmac_f32 v203, v177, v177
    v_fmac_f32 v202, v178, v178
    v_fmac_f32 v203, v179, v179
    v_fmac_f32 v202, v180, v180
    v_fmac_f32 v203, v181, v181
    v_fmac_f32 v202, v182, v182
    v_fmac_f32 v203, v183, v183
    v_fmac_f32 v202, v184, v184
    v_fmac_f32 v203, v185, v185
    v_fmac_f32 v202, v186, v186
    v_fmac_f32 v203, v187, v187
    v_fmac_f32 v202, v188, v188
    v_fmac_f32 v203, v189, v189
    v_fmac_f32 v202, v190, v190
    v_fmac_f32 v203, v191, v191
    v_add_f32 v202, v202, v203
    s_nop 1
    v_add_f32_dpp v202, v202, v202 row_ror:8 row_mask:0xf bank_mask:0xf
    s_nop 1
    v_add_f32_dpp v202, v202, v202 row_ror:4 row_mask:0xf bank_mask:0xf
    s_nop 1
    v_add_f32_dpp v202, v202, v202 row_ror:2 row_mask:0xf bank_mask:0xf
    s_nop 1
    v_add_f32_dpp v202, v202, v202 row_ror:1 row_mask:0xf bank_mask:0xf
    v_mov_b32 v203, v202
    s_nop 1
    v_permlane16_swap_b32 v202, v203
    v_add_f32 v202, v202, v203
    v_mul_f32 v202, 0x3ae38e39, v202
    v_cvt_pk_bf16_f32 v204, v200, v200
    v_lshlrev_b32 v200, 16, v204
    v_cvt_pk_bf16_f32 v204, v202, v202
    v_lshlrev_b32 v202, 16, v204
    v_add_f32 v202, 0x3727c5ac, v202
    v_cvt_pk_bf16_f32 v204, v202, v202
    v_lshlrev_b32 v202, 16, v204
    v_sqrt_f32 v202, v202
    s_nop 0
    v_cvt_pk_bf16_f32 v204, v202, v202
    v_lshlrev_b32 v202, 16, v204
    v_readlane_b32 s48, v200, 0
    v_readlane_b32 s49, v200, 32
    v_readlane_b32 s50, v202, 0
    v_readlane_b32 s51, v202, 32
    v_and_b32 v204, 1, v0
    v_cmp_eq_u32 vcc, 1, v204
    v_mov_b32 v200, s48
    v_mov_b32 v201, s49
    v_mov_b32 v202, s50
    v_mov_b32 v203, s51
    v_cndmask_b32 v200, v200, v201, vcc
    v_cndmask_b32 v202, v202, v203, vcc
    v_rcp_f32 v203, v202
    s_waitcnt lgkmcnt(0)
    v_lshlrev_b32 v168, 16, v92
    v_and_b32 v169, 0xffff0000, v92
    v_sub_f32 v168, v168, v200
    v_sub_f32 v169, v169, v200
    v_cvt_pk_bf16_f32 v170, v168, v169
    v_lshlrev_b32 v168, 16, v170
    v_and_b32 v169, 0xffff0000, v170
    v_mul_f32 v170, v168, v203
    v_mul_f32 v171, v169, v203
    v_fma_f32 v172, -v170, v202, v168
    v_fma_f32 v173, -v171, v202, v169
    v_fma_f32 v170, v172, v203, v170
    v_fma_f32 v171, v173, v203, v171
    v_cvt_pk_bf16_f32 v6, v170, v171
    v_lshlrev_b32 v174, 16, v93
    v_and_b32 v175, 0xffff0000, v93
    v_sub_f32 v174, v174, v200
    v_sub_f32 v175, v175, v200
    v_cvt_pk_bf16_f32 v176, v174, v175
    v_lshlrev_b32 v174, 16, v176
    v_and_b32 v175, 0xffff0000, v176
    v_mul_f32 v176, v174, v203
    v_mul_f32 v177, v175, v203
    v_fma_f32 v178, -v176, v202, v174
    v_fma_f32 v179, -v177, v202, v175
    v_fma_f32 v176, v178, v203, v176
    v_fma_f32 v177, v179, v203, v177
    v_cvt_pk_bf16_f32 v7, v176, v177
    v_lshlrev_b32 v180, 16, v94
    v_and_b32 v181, 0xffff0000, v94
    v_sub_f32 v180, v180, v200
    v_sub_f32 v181, v181, v200
    v_cvt_pk_bf16_f32 v182, v180, v181
    v_lshlrev_b32 v180, 16, v182
    v_and_b32 v181, 0xffff0000, v182
    v_mul_f32 v182, v180, v203
    v_mul_f32 v183, v181, v203
    v_fma_f32 v184, -v182, v202, v180
    v_fma_f32 v185, -v183, v202, v181
    v_fma_f32 v182, v184, v203, v182
    v_fma_f32 v183, v185, v203, v183
    v_cvt_pk_bf16_f32 v8, v182, v183
    v_lshlrev_b32 v186, 16, v95
    v_and_b32 v187, 0xffff0000, v95
    v_sub_f32 v186, v186, v200
    v_sub_f32 v187, v187, v200
    v_cvt_pk_bf16_f32 v188, v186, v187
    v_lshlrev_b32 v186, 16, v188
    v_and_b32 v187, 0xffff0000, v188
    v_mul_f32 v188, v186, v203
    v_mul_f32 v189, v187, v203
    v_fma_f32 v190, -v188, v202, v186
    v_fma_f32 v191, -v189, v202, v187
    v_fma_f32 v188, v190, v203, v188
    v_fma_f32 v189, v191, v203, v189
    v_cvt_pk_bf16_f32 v9, v188, v189
    v_lshlrev_b32 v192, 16, v96
    v_mov_b32 v193, v200
    v_sub_f32 v192, v192, v200
    v_sub_f32 v193, v193, v200
    v_cvt_pk_bf16_f32 v194, v192, v193
    v_lshlrev_b32 v192, 16, v194
    v_and_b32 v193, 0xffff0000, v194
    v_mul_f32 v194, v192, v203
    v_mul_f32 v195, v193, v203
    v_fma_f32 v196, -v194, v202, v192
    v_fma_f32 v197, -v195, v202, v193
    v_fma_f32 v194, v196, v203, v194
    v_fma_f32 v195, v197, v203, v195
    v_cvt_pk_bf16_f32 v10, v194, v195
    v_and_b32 v10, 0xffff, v10
    v_mov_b32 v11, 0
    s_waitcnt lgkmcnt(0)
    s_mul_i32 s36, s63, 0x9E3779B1
    s_add_u32 s36, s36, 0x7F4A7C15
    s_getreg_b32 s51, hwreg(HW_REG_XCC_ID)
    s_and_b32 s51, s51, 15
    s_cmp_lg_u32 s3, 0
    s_cbranch_scc1 L_noxt
    v_mov_b32 v200, s51
    v_mov_b32 v201, s36
    s_lshl_b32 s62, s46, 3
    s_add_u32 s62, s62, 892928
    v_mov_b32 v202, 0
    s_mov_b64 exec, 1
    buffer_store_dwordx2 v[200:201], v202, s[28:31], s62 offen sc1
    s_mov_b64 exec, -1
L_noxt:
    s_add_u32 s62, s47, 0
    buffer_load_dwordx4 v[16:19], v14, s[8:11], s62 offen offset:0 nt
    s_add_u32 s62, s47, 8192
    buffer_load_dwordx4 v[20:23], v14, s[8:11], s62 offen offset:0 nt
    s_cmp_eq_u32 s100, 0
    s_cbranch_scc1 L_E_skip
    s_waitcnt vmcnt(2)
    v_perm_b32 v200, v148, v144, s37
    v_perm_b32 v201, v156, v152, s37
    v_perm_b32 v202, v164, v160, s37
    v_perm_b32 v203, v244, v240, s37
    s_nop 1
    v_mfma_f32_16x16x32_bf16 v[168:171], v[6:9], v[200:203], 0
    v_perm_b32 v204, v148, v144, s38
    v_perm_b32 v205, v156, v152, s38
    v_perm_b32 v206, v164, v160, s38
    v_perm_b32 v207, v244, v240, s38
    s_nop 1
    v_mfma_f32_16x16x32_bf16 v[172:175], v[6:9], v[204:207], 0
    v_perm_b32 v208, v149, v145, s37
    v_perm_b32 v209, v157, v153, s37
    v_perm_b32 v210, v165, v161, s37
    v_perm_b32 v211, v245, v241, s37
    s_nop 1
    v_mfma_f32_16x16x32_bf16 v[176:179], v[6:9], v[208:211], 0
    v_perm_b32 v212, v149, v145, s38
    v_perm_b32 v213, v157, v153, s38
    v_perm_b32 v214, v165, v161, s38
    v_perm_b32 v215, v245, v241, s38
    s_nop 1
    v_mfma_f32_16x16x32_bf16 v[180:183], v[6:9], v[212:215], 0
    v_perm_b32 v200, v150, v146, s37
    v_perm_b32 v201, v158, v154, s37
    v_perm_b32 v202, v166, v162, s37
    v_perm_b32 v203, v246, v242, s37
    s_nop 1
    v_mfma_f32_16x16x32_bf16 v[184:187], v[6:9], v[200:203], 0
    v_perm_b32 v204, v150, v146, s38
    v_perm_b32 v205, v158, v154, s38
    v_perm_b32 v206, v166, v162, s38
    v_perm_b32 v207, v246, v242, s38
    s_nop 1
    v_mfma_f32_16x16x32_bf16 v[188:191], v[6:9], v[204:207], 0
    v_perm_b32 v208, v151, v147, s37
    v_perm_b32 v209, v159, v155, s37
    v_perm_b32 v210, v167, v163, s37
    v_perm_b32 v211, v247, v243, s37
    s_nop 1
    v_mfma_f32_16x16x32_bf16 v[192:195], v[6:9], v[208:211], 0
    v_perm_b32 v212, v151, v147, s38
    v_perm_b32 v213, v159, v155, s38
    v_perm_b32 v214, v167, v163, s38
    v_perm_b32 v215, v247, v243, s38
    s_nop 1
    v_mfma_f32_16x16x32_bf16 v[196:199], v[6:9], v[212:215], 0
    v_mov_b32 v217, 0
    v_mov_b32 v219, 0
    v_and_b32 v216, 0xffff, v248
    s_nop 1
    v_mfma_f32_16x16x16_bf16 v[168:171], v[10:11], v[216:217], v[168:171]
    v_lshrrev_b32 v218, 16, v248
    s_nop 1
    v_mfma_f32_16x16x16_bf16 v[172:175], v[10:11], v[218:219], v[172:175]
    v_and_b32 v216, 0xffff, v249
    s_nop 1
    v_mfma_f32_16x16x16_bf16 v[176:179], v[10:11], v[216:217], v[176:179]
    v_lshrrev_b32 v218, 16, v249
    s_nop 1
    v_mfma_f32_16x16x16_bf16 v[180:183], v[10:11], v[218:219], v[180:183]
    v_and_b32 v216, 0xffff, v250
    s_nop 1
    v_mfma_f32_16x16x16_bf16 v[184:187], v[10:11], v[216:217], v[184:187]
    v_lshrrev_b32 v218, 16, v250
    s_nop 1
    v_mfma_f32_16x16x16_bf16 v[188:191], v[10:11], v[218:219], v[188:191]
    v_and_b32 v216, 0xffff, v251
    s_nop 1
    v_mfma_f32_16x16x16_bf16 v[192:195], v[10:11], v[216:217], v[192:195]
    v_lshrrev_b32 v218, 16, v251
    s_nop 1
    v_mfma_f32_16x16x16_bf16 v[196:199], v[10:11], v[218:219], v[196:199]
    s_lshl_b32 s62, s3, 9
    v_lshlrev_b32 v12, 5, v5
    v_add_u32 v12, s62, v12
    v_add_f32_dpp v168, v170, v168 row_shl:8 row_mask:0xf bank_mask:0xf
    v_add_f32_dpp v169, v171, v169 row_shl:8 row_mask:0xf bank_mask:0xf
    v_add_f32_dpp v172, v174, v172 row_shl:8 row_mask:0xf bank_mask:0xf
    v_add_f32_dpp v173, v175, v173 row_shl:8 row_mask:0xf bank_mask:0xf
    v_add_f32_dpp v176, v178, v176 row_shl:8 row_mask:0xf bank_mask:0xf
    v_add_f32_dpp v177, v179, v177 row_shl:8 row_mask:0xf bank_mask:0xf
    v_add_f32_dpp v180, v182, v180 row_shl:8 row_mask:0xf bank_mask:0xf
    v_add_f32_dpp v181, v183, v181 row_shl:8 row_mask:0xf bank_mask:0xf
    v_add_f32_dpp v184, v186, v184 row_shl:8 row_mask:0xf bank_mask:0xf
    v_add_f32_dpp v185, v187, v185 row_shl:8 row_mask:0xf bank_mask:0xf
    v_add_f32_dpp v188, v190, v188 row_shl:8 row_mask:0xf bank_mask:0xf
    v_add_f32_dpp v189, v191, v189 row_shl:8 row_mask:0xf bank_mask:0xf
    v_add_f32_dpp v192, v194, v192 row_shl:8 row_mask:0xf bank_mask:0xf
    v_add_f32_dpp v193, v195, v193 row_shl:8 row_mask:0xf bank_mask:0xf
    v_add_f32_dpp v196, v198, v196 row_shl:8 row_mask:0xf bank_mask:0xf
    v_add_f32_dpp v197, v199, v197 row_shl:8 row_mask:0xf bank_mask:0xf
    s_mov_b64 exec, 0xff
    ds_write2_b32 v12, v168, v169 offset0:0 offset1:64
    ds_write2_b32 v12, v172, v173 offset0:1 offset1:65
    ds_write2_b32 v12, v176, v177 offset0:2 offset1:66
    ds_write2_b32 v12, v180, v181 offset0:3 offset1:67
    ds_write2_b32 v12, v184, v185 offset0:4 offset1:68
    ds_write2_b32 v12, v188, v189 offset0:5 offset1:69
    ds_write2_b32 v12, v192, v193 offset0:6 offset1:70
    ds_write2_b32 v12, v196, v197 offset0:7 offset1:71
    s_mov_b64 exec, -1
    v_mov_b32 v200, 4608
    v_mov_b32 v201, 1
    s_waitcnt lgkmcnt(0)
    s_mov_b64 exec, 1
    ds_add_rtn_u32 v201, v200, v201
    s_waitcnt lgkmcnt(0)
    v_readfirstlane_b32 s62, v201
    s_mov_b64 exec, -1
    s_cmp_lg_u32 s62, 7
    s_cbranch_scc1 L_E_skip
    v_lshlrev_b32 v12, 3, v0
    ds_read_b64 v[168:169], v12 offset:0
    ds_read_b64 v[170:171], v12 offset:512
    ds_read_b64 v[172:173], v12 offset:1024
    ds_read_b64 v[174:175], v12 offset:1536
    ds_read_b64 v[176:177], v12 offset:2048
    ds_read_b64 v[178:179], v12 offset:2560
    ds_read_b64 v[180:181], v12 offset:3072
    ds_read_b64 v[182:183], v12 offset:3584
    s_waitcnt lgkmcnt(0)
    v_add_f32 v168, v168, v170
    v_add_f32 v169, v169, v171
    v_add_f32 v168, v168, v172
    v_add_f32 v169, v169, v173
    v_add_f32 v168, v168, v174
    v_add_f32 v169, v169, v175
    v_add_f32 v168, v168, v176
    v_add_f32 v169, v169, v177
    v_add_f32 v168, v168, v178
    v_add_f32 v169, v169, v179
    v_add_f32 v168, v168, v180
    v_add_f32 v169, v169, v181
    v_add_f32 v168, v168, v182
    v_add_f32 v169, v169, v183
    s_cmp_eq_u32 s100, 1
    s_cbranch_scc1 L_E_pubfinal
    s_cmp_eq_u32 s100, 3
    s_cbranch_scc1 L_E_pubpart
    v_mov_b32 v8, v168
    v_mov_b32 v9, v169
    s_mov_b32 s101, 1
    s_branch L_E_skip
L_E_pubpart:
    v_mov_b32 v200, v168
    v_mov_b32 v201, s36
    v_mov_b32 v202, v169
    v_mov_b32 v203, s36
    s_lshl_b32 s62, s97, 10
    s_add_u32 s62, s62, 925696
    v_lshlrev_b32 v12, 4, v0
    buffer_store_dwordx4 v[200:203], v12, s[28:31], s62 offen sc1
    s_branch L_E_skip
L_E_pubfinal:
    s_nop 0
    v_cvt_pk_bf16_f32 v200, v168, v169
    v_mov_b32 v201, s36
    v_lshrrev_b32 v12, 5, v0
    v_mul_lo_u32 v12, v12, s68
    v_and_b32 v13, 31, v0
    v_lshl_add_u32 v12, v13, 3, v12
    s_lshl_b32 s62, s66, 8
    s_add_u32 s62, s62, s67
    buffer_store_dwordx2 v[200:201], v12, s[28:31], s62 offen sc1
L_E_skip:
    s_mul_i32 s62, s3, 4352
    s_add_u32 s62, s62, 16384
    v_mul_u32_u24 v230, 272, v2
    v_lshl_add_u32 v230, v3, 4, v230
    v_add_u32 v230, s62, v230
    v_and_b32 v231, 3, v3
    v_lshlrev_b32 v231, 2, v231
    v_lshrrev_b32 v12, 2, v3
    v_add_u32 v231, v231, v12
    v_mul_u32_u24 v231, 272, v231
    v_lshl_add_u32 v231, v2, 4, v231
    v_add_u32 v231, s62, v231
    s_add_u32 s62, s47, 16384
    buffer_load_dwordx4 v[24:27], v14, s[8:11], s62 offen offset:0 nt
    s_waitcnt vmcnt(3)
    s_cmp_eq_u32 s101, 0
    s_cbranch_scc1 L_hp1
    s_lshl_b32 s99, s97, 10
    s_add_u32 s99, s99, 925696
    v_lshlrev_b32 v10, 4, v0
    buffer_load_dwordx4 v[252:255], v10, s[28:31], s99 offen sc1
L_hp1:
    s_add_u32 s62, s47, 24576
    buffer_load_dwordx4 v[28:31], v14, s[8:11], s62 offen offset:0 nt
    s_waitcnt vmcnt(3)
    s_add_u32 s62, s47, 32768
    buffer_load_dwordx4 v[32:35], v14, s[8:11], s62 offen offset:0 nt
    s_waitcnt vmcnt(3)
    s_add_u32 s62, s47, 40960
    buffer_load_dwordx4 v[36:39], v14, s[8:11], s62 offen offset:0 nt
    s_waitcnt vmcnt(3)
    s_add_u32 s62, s47, 49152
    buffer_load_dwordx4 v[40:43], v14, s[8:11], s62 offen offset:0 nt
    s_waitcnt vmcnt(3)
    ds_write_b128 v230, v[16:19] offset:0
    ds_write_b128 v230, v[20:23] offset:1088
    ds_write_b128 v230, v[24:27] offset:2176
    ds_write_b128 v230, v[28:31] offset:3264
    ds_read_b128 v[16:19], v231 offset:0
    ds_read_b128 v[20:23], v231 offset:64
    ds_read_b128 v[24:27], v231 offset:128
    ds_read_b128 v[28:31], v231 offset:192
    s_cmp_eq_u32 s101, 0
    s_cbranch_scc1 L_hps_1
    s_waitcnt vmcnt(4)
    v_cmp_eq_u32 vcc, s36, v253
    v_cmp_eq_u32 s[62:63], s36, v255
    s_nop 1
    s_and_b64 vcc, vcc, s[62:63]
    s_nop 1
    s_cmp_eq_u64 vcc, exec
    s_cbranch_scc0 L_hpr_2
    v_add_f32 v8, v8, v252
    v_add_f32 v9, v9, v254
    v_cvt_pk_bf16_f32 v8, v8, v9
    v_mov_b32 v9, s36
    v_lshrrev_b32 v12, 5, v0
    v_mul_lo_u32 v12, v12, s68
    v_and_b32 v13, 31, v0
    v_lshl_add_u32 v12, v13, 3, v12
    s_lshl_b32 s62, s66, 8
    s_add_u32 s62, s62, s67
    buffer_store_dwordx2 v[8:9], v12, s[28:31], s62 offen sc1
    s_mov_b32 s101, 0
    s_branch L_hps_1
L_hpr_2:
    buffer_load_dwordx4 v[252:255], v10, s[28:31], s99 offen sc1
L_hps_1:
    s_add_u32 s62, s47, 57344
    buffer_load_dwordx4 v[44:47], v14, s[8:11], s62 offen offset:0 nt
    s_waitcnt vmcnt(3)
    s_add_u32 s62, s47, 65536
    buffer_load_dwordx4 v[48:51], v14, s[8:11], s62 offen offset:0 nt
    s_waitcnt vmcnt(3)
    s_add_u32 s62, s47, 73728
    buffer_load_dwordx4 v[52:55], v14, s[8:11], s62 offen offset:0 nt
    s_waitcnt vmcnt(3)
    s_add_u32 s62, s47, 81920
    buffer_load_dwordx4 v[56:59], v14, s[8:11], s62 offen offset:0 nt
    s_waitcnt vmcnt(3)
    ds_write_b128 v230, v[32:35] offset:0
    ds_write_b128 v230, v[36:39] offset:1088
    ds_write_b128 v230, v[40:43] offset:2176
    ds_write_b128 v230, v[44:47] offset:3264
    ds_read_b128 v[32:35], v231 offset:0
    ds_read_b128 v[36:39], v231 offset:64
    ds_read_b128 v[40:43], v231 offset:128
    ds_read_b128 v[44:47], v231 offset:192
    s_cmp_eq_u32 s101, 0
    s_cbranch_scc1 L_hp2
    s_waitcnt vmcnt(4)
    s_mov_b32 s96, 0
L_hp_chk:
    v_cmp_eq_u32 vcc, s36, v253
    v_cmp_eq_u32 s[62:63], s36, v255
    s_nop 1
    s_and_b64 vcc, vcc, s[62:63]
    s_nop 1
    s_cmp_eq_u64 vcc, exec
    s_cbranch_scc1 L_hp_ok
    s_add_u32 s96, s96, 1
    s_cmp_gt_u32 s96, 20000
    s_cbranch_scc1 L_hp_ok
    s_sleep 1
    buffer_load_dwordx4 v[252:255], v10, s[28:31], s99 offen sc1
    s_waitcnt vmcnt(0)
    s_branch L_hp_chk
L_hp_ok:
    v_add_f32 v8, v8, v252
    v_add_f32 v9, v9, v254
    v_cvt_pk_bf16_f32 v8, v8, v9
    v_mov_b32 v9, s36
    v_lshrrev_b32 v12, 5, v0
    v_mul_lo_u32 v12, v12, s68
    v_and_b32 v13, 31, v0
    v_lshl_add_u32 v12, v13, 3, v12
    s_lshl_b32 s62, s66, 8
    s_add_u32 s62, s62, s67
    buffer_store_dwordx2 v[8:9], v12, s[28:31], s62 offen sc1
    s_mov_b32 s101, 0
L_hp2:
    s_add_u32 s62, s47, 90112
    buffer_load_dwordx4 v[60:63], v14, s[8:11], s62 offen offset:0 nt
    s_waitcnt vmcnt(3)
    s_add_u32 s62, s47, 98304
    buffer_load_dwordx4 v[64:67], v14, s[8:11], s62 offen offset:0 nt
    s_waitcnt vmcnt(3)
    s_add_u32 s62, s47, 106496
    buffer_load_dwordx4 v[68:71], v14, s[8:11], s62 offen offset:0 nt
    s_waitcnt vmcnt(3)
    s_add_u32 s62, s47, 114688
    buffer_load_dwordx4 v[72:75], v14, s[8:11], s62 offen offset:0 nt
    s_waitcnt vmcnt(3)
    ds_write_b128 v230, v[48:51] offset:0
    ds_write_b128 v230, v[52:55] offset:1088
    ds_write_b128 v230, v[56:59] offset:2176
    ds_write_b128 v230, v[60:63] offset:3264
    ds_read_b128 v[48:51], v231 offset:0
    ds_read_b128 v[52:55], v231 offset:64
    ds_read_b128 v[56:59], v231 offset:128
    ds_read_b128 v[60:63], v231 offset:192
    s_add_u32 s62, s47, 122880
    buffer_load_dwordx4 v[76:79], v14, s[8:11], s62 offen offset:0 nt
    s_waitcnt vmcnt(3)
    s_lshr_b32 s62, s46, 7
    s_lshl_b32 s62, s62, 14
    s_bfe_u32 s64, s46, 0x40003
    s_lshl_b32 s64, s64, 10
    s_add_u32 s62, s62, s64
    s_add_u32 s52, s62, 4096
    s_lshl_b32 s62, s39, 3
    s_mul_i32 s62, s62, s3
    s_add_u32 s62, s62, s43
    v_mul_lo_u32 v14, v4, s39
    v_add_u32 v14, s62, v14
    v_mul_u32_u24 v14, 1152, v14
    s_lshl_b32 s62, s41, 7
    v_lshl_add_u32 v14, v5, 4, v14
    v_add_u32 v14, s62, v14
    s_movk_i32 s53, 4608
    v_mov_b32 v200, 4612
    v_mov_b32 v201, 1
    s_waitcnt lgkmcnt(0)
    s_mov_b64 exec, 1
    ds_add_rtn_u32 v201, v200, v201
    s_waitcnt lgkmcnt(0)
    v_readfirstlane_b32 s62, v201
    s_mov_b64 exec, -1
    s_cmp_lg_u32 s62, 0
    s_cbranch_scc1 L_q_notme
    buffer_load_dwordx4 v[240:243], v15, s[28:31], s52 offen sc1
    s_waitcnt vmcnt(0)
    s_mov_b32 s96, 0
L_q_chk_3:
    v_cmp_eq_u32 vcc, s36, v241
    v_cmp_eq_u32 s[98:99], s36, v243
    s_nop 1
    s_and_b64 vcc, vcc, s[98:99]
    s_nop 1
    s_cmp_eq_u64 vcc, exec
    s_cbranch_scc1 L_q_ok_4
    s_add_u32 s96, s96, 1
    s_cmp_gt_u32 s96, 20000
    s_cbranch_scc1 L_q_ok_4
    s_sleep 1
    buffer_load_dwordx4 v[240:243], v15, s[28:31], s52 offen sc1
    s_waitcnt vmcnt(0)
    s_branch L_q_chk_3
L_q_ok_4:
    v_lshlrev_b32 v12, 3, v0
    v_add_u32 v12, 4096, v12
    ds_write2_b32 v12, v240, v242 offset0:0 offset1:1
    v_mov_b32 v12, 4616
    v_mov_b32 v13, 1
    s_waitcnt lgkmcnt(0)
    s_mov_b64 exec, 1
    ds_write_b32 v12, v13
    s_mov_b64 exec, -1
L_q_notme:
    s_add_u32 s62, s47, 0
    buffer_load_dwordx4 v[80:83], v15, s[12:15], s62 offen nt
    s_add_u32 s62, s47, 8192
    buffer_load_dwordx4 v[84:87], v15, s[12:15], s62 offen nt
    s_add_u32 s62, s47, 16384
    buffer_load_dwordx4 v[88:91], v15, s[12:15], s62 offen nt
    s_waitcnt vmcnt(3)
    ds_write_b128 v230, v[64:67] offset:0
    ds_write_b128 v230, v[68:71] offset:1088
    ds_write_b128 v230, v[72:75] offset:2176
    ds_write_b128 v230, v[76:79] offset:3264
    ds_read_b128 v[64:67], v231 offset:0
    ds_read_b128 v[68:71], v231 offset:64
    ds_read_b128 v[72:75], v231 offset:128
    ds_read_b128 v[76:79], v231 offset:192
    v_mov_b32 v12, 4616
    s_mov_b32 s96, 0
L_qwait:
    ds_read_b32 v13, v12
    s_waitcnt lgkmcnt(0)
    v_readfirstlane_b32 s62, v13
    s_nop 0
    s_cmp_lg_u32 s62, 0
    s_cbranch_scc1 L_qready
    s_add_u32 s96, s96, 1
    s_cmp_gt_u32 s96, 400000
    s_cbranch_scc1 L_qready
    s_sleep 1
    s_branch L_qwait
L_qready:
    v_and_b32 v13, 1, v0
    v_lshlrev_b32 v13, 8, v13
    v_lshl_add_u32 v13, v2, 4, v13
    ds_read_b128 v[240:243], v13 offset:4096
    ds_read_b128 v[244:247], v13 offset:4160
    ds_read_b128 v[248:251], v13 offset:4224
    ds_read_b128 v[252:255], v13 offset:4288
    s_waitcnt lgkmcnt(0)
    v_mfma_f32_16x16x32_bf16 v[216:219], v[16:19], v[240:243], 0
    v_mfma_f32_16x16x32_bf16 v[220:223], v[32:35], v[240:243], 0
    v_mfma_f32_16x16x32_bf16 v[224:227], v[48:51], v[240:243], 0
    v_mfma_f32_16x16x32_bf16 v[228:231], v[64:67], v[240:243], 0
    v_mfma_f32_16x16x32_bf16 v[216:219], v[20:23], v[244:247], v[216:219]
    v_mfma_f32_16x16x32_bf16 v[220:223], v[36:39], v[244:247], v[220:223]
    v_mfma_f32_16x16x32_bf16 v[224:227], v[52:55], v[244:247], v[224:227]
    v_mfma_f32_16x16x32_bf16 v[228:231], v[68:71], v[244:247], v[228:231]
    v_mfma_f32_16x16x32_bf16 v[216:219], v[24:27], v[248:251], v[216:219]
    v_mfma_f32_16x16x32_bf16 v[220:223], v[40:43], v[248:251], v[220:223]
    v_mfma_f32_16x16x32_bf16 v[224:227], v[56:59], v[248:251], v[224:227]
    v_mfma_f32_16x16x32_bf16 v[228:231], v[72:75], v[248:251], v[228:231]
    v_mfma_f32_16x16x32_bf16 v[216:219], v[28:31], v[252:255], v[216:219]
    v_mfma_f32_16x16x32_bf16 v[220:223], v[44:47], v[252:255], v[220:223]
    v_mfma_f32_16x16x32_bf16 v[224:227], v[60:63], v[252:255], v[224:227]
    v_mfma_f32_16x16x32_bf16 v[228:231], v[76:79], v[252:255], v[228:231]
    s_add_u32 s62, s47, 24576
    buffer_load_dwordx4 v[92:95], v15, s[12:15], s62 offen nt
    s_add_u32 s62, s47, 32768
    buffer_load_dwordx4 v[96:99], v15, s[12:15], s62 offen nt
    s_mov_b32 s62, 0x3db504f3
    v_cvt_pk_bf16_f32 v200, v216, v217
    v_lshlrev_b32 v216, 16, v200
    v_and_b32 v217, 0xffff0000, v200
    v_mul_f32 v216, s62, v216
    v_mul_f32 v217, s62, v217
    v_cvt_pk_bf16_f32 v200, v216, v217
    v_lshlrev_b32 v216, 16, v200
    v_and_b32 v217, 0xffff0000, v200
    v_cvt_pk_bf16_f32 v201, v218, v219
    v_lshlrev_b32 v218, 16, v201
    v_and_b32 v219, 0xffff0000, v201
    v_mul_f32 v218, s62, v218
    v_mul_f32 v219, s62, v219
    v_cvt_pk_bf16_f32 v201, v218, v219
    v_lshlrev_b32 v218, 16, v201
    v_and_b32 v219, 0xffff0000, v201
    v_cvt_pk_bf16_f32 v202, v220, v221
    v_lshlrev_b32 v220, 16, v202
    v_and_b32 v221, 0xffff0000, v202
    v_mul_f32 v220, s62, v220
    v_mul_f32 v221, s62, v221
    v_cvt_pk_bf16_f32 v202, v220, v221
    v_lshlrev_b32 v220, 16, v202
    v_and_b32 v221, 0xffff0000, v202
    v_cvt_pk_bf16_f32 v203, v222, v223
    v_lshlrev_b32 v222, 16, v203
    v_and_b32 v223, 0xffff0000, v203
    v_mul_f32 v222, s62, v222
    v_mul_f32 v223, s62, v223
    v_cvt_pk_bf16_f32 v203, v222, v223
    v_lshlrev_b32 v222, 16, v203
    v_and_b32 v223, 0xffff0000, v203
    v_cvt_pk_bf16_f32 v200, v224, v225
    v_lshlrev_b32 v224, 16, v200
    v_and_b32 v225, 0xffff0000, v200
    v_mul_f32 v224, s62, v224
    v_mul_f32 v225, s62, v225
    v_cvt_pk_bf16_f32 v200, v224, v225
    v_lshlrev_b32 v224, 16, v200
    v_and_b32 v225, 0xffff0000, v200
    v_cvt_pk_bf16_f32 v201, v226, v227
    v_lshlrev_b32 v226, 16, v201
    v_and_b32 v227, 0xffff0000, v201
    v_mul_f32 v226, s62, v226
    v_mul_f32 v227, s62, v227
    v_cvt_pk_bf16_f32 v201, v226, v227
    v_lshlrev_b32 v226, 16, v201
    v_and_b32 v227, 0xffff0000, v201
    v_cvt_pk_bf16_f32 v202, v228, v229
    v_lshlrev_b32 v228, 16, v202
    v_and_b32 v229, 0xffff0000, v202
    v_mul_f32 v228, s62, v228
    v_mul_f32 v229, s62, v229
    v_cvt_pk_bf16_f32 v202, v228, v229
    v_lshlrev_b32 v228, 16, v202
    v_and_b32 v229, 0xffff0000, v202
    v_cvt_pk_bf16_f32 v203, v230, v231
    v_lshlrev_b32 v230, 16, v203
    v_and_b32 v231, 0xffff0000, v203
    v_mul_f32 v230, s62, v230
    v_mul_f32 v231, s62, v231
    v_cvt_pk_bf16_f32 v203, v230, v231
    v_lshlrev_b32 v230, 16, v203
    v_and_b32 v231, 0xffff0000, v203
    v_max3_f32 v12, v216, v217, v218
    v_max3_f32 v12, v12, v219, v220
    v_max3_f32 v12, v12, v221, v222
    v_max3_f32 v12, v12, v223, v224
    v_max3_f32 v12, v12, v225, v226
    v_max3_f32 v12, v12, v227, v228
    v_max3_f32 v12, v12, v229, v230
    v_max_f32 v12, v12, v231
    v_mov_b32 v200, v12
    s_nop 1
    v_permlane16_swap_b32 v12, v200
    v_max_f32 v12, v12, v200
    v_mov_b32 v200, v12
    s_nop 1
    v_permlane32_swap_b32 v12, v200
    v_max_f32 v12, v12, v200
    s_mov_b32 s62, 0x3fb8aa3b
    v_sub_f32 v216, v216, v12
    v_sub_f32 v217, v217, v12
    v_sub_f32 v218, v218, v12
    v_sub_f32 v219, v219, v12
    v_sub_f32 v220, v220, v12
    v_sub_f32 v221, v221, v12
    v_sub_f32 v222, v222, v12
    v_sub_f32 v223, v223, v12
    v_sub_f32 v224, v224, v12
    v_sub_f32 v225, v225, v12
    v_sub_f32 v226, v226, v12
    v_sub_f32 v227, v227, v12
    v_sub_f32 v228, v228, v12
    v_sub_f32 v229, v229, v12
    v_sub_f32 v230, v230, v12
    v_sub_f32 v231, v231, v12
    v_mul_f32 v216, s62, v216
    v_mul_f32 v217, s62, v217
    v_mul_f32 v218, s62, v218
    v_mul_f32 v219, s62, v219
    v_mul_f32 v220, s62, v220
    v_mul_f32 v221, s62, v221
    v_mul_f32 v222, s62, v222
    v_mul_f32 v223, s62, v223
    v_mul_f32 v224, s62, v224
    v_mul_f32 v225, s62, v225
    v_mul_f32 v226, s62, v226
    v_mul_f32 v227, s62, v227
    v_mul_f32 v228, s62, v228
    v_mul_f32 v229, s62, v229
    v_mul_f32 v230, s62, v230
    v_mul_f32 v231, s62, v231
    v_exp_f32 v216, v216
    v_exp_f32 v217, v217
    v_exp_f32 v218, v218
    v_exp_f32 v219, v219
    v_exp_f32 v220, v220
    v_exp_f32 v221, v221
    v_exp_f32 v222, v222
    v_exp_f32 v223, v223
    v_exp_f32 v224, v224
    v_exp_f32 v225, v225
    v_exp_f32 v226, v226
    v_exp_f32 v227, v227
    v_exp_f32 v228, v228
    v_exp_f32 v229, v229
    v_exp_f32 v230, v230
    v_exp_f32 v231, v231
    v_add_f32 v13, v216, v217
    v_add_f32 v13, v13, v218
    v_add_f32 v13, v13, v219
    v_add_f32 v13, v13, v220
    v_add_f32 v13, v13, v221
    v_add_f32 v13, v13, v222
    v_add_f32 v13, v13, v223
    v_add_f32 v13, v13, v224
    v_add_f32 v13, v13, v225
    v_add_f32 v13, v13, v226
    v_add_f32 v13, v13, v227
    v_add_f32 v13, v13, v228
    v_add_f32 v13, v13, v229
    v_add_f32 v13, v13, v230
    v_add_f32 v13, v13, v231
    v_cvt_pk_bf16_f32 v232, v216, v217
    v_cvt_pk_bf16_f32 v233, v218, v219
    v_cvt_pk_bf16_f32 v234, v220, v221
    v_cvt_pk_bf16_f32 v235, v222, v223
    v_cvt_pk_bf16_f32 v236, v224, v225
    v_cvt_pk_bf16_f32 v237, v226, v227
    v_cvt_pk_bf16_f32 v238, v228, v229
    v_cvt_pk_bf16_f32 v239, v230, v231
    v_mov_b32 v200, v13
    s_nop 1
    v_permlane16_swap_b32 v13, v200
    v_add_f32 v13, v13, v200
    v_mov_b32 v200, v13
    s_nop 1
    v_permlane32_swap_b32 v13, v200
    v_add_f32 v13, v13, v200
    s_lshl_b32 s62, s3, 4
    s_add_u32 s62, s62, 4864
    v_lshl_add_u32 v200, v0, 3, s62
    s_mov_b64 exec, 3
    ds_write2_b32 v200, v12, v13 offset0:0 offset1:1
    s_mov_b64 exec, -1
    s_mov_b32 s50, 0
    s_cmp_lg_u32 s40, 0
    s_cbranch_scc1 L_noxl
    v_bfe_u32 v200, v0, 3, 1
    v_lshlrev_b32 v200, 7, v200
    v_and_b32 v201, 7, v0
    v_add_u32 v200, v200, v201
    s_lshl_b32 s62, s42, 3
    v_add_u32 v200, s62, v200
    v_lshlrev_b32 v200, 3, v200
    s_mov_b32 s62, 892928
    buffer_load_dwordx2 v[76:77], v200, s[28:31], s62 offen sc1
L_noxl:
    s_add_u32 s62, s47, 40960
    buffer_load_dwordx4 v[100:103], v15, s[12:15], s62 offen nt
    s_waitcnt vmcnt(3)
    s_add_u32 s62, s47, 49152
    buffer_load_dwordx4 v[104:107], v15, s[12:15], s62 offen nt
    s_waitcnt vmcnt(3)
    s_add_u32 s62, s47, 57344
    buffer_load_dwordx4 v[108:111], v15, s[12:15], s62 offen nt
    s_waitcnt vmcnt(3)
    s_add_u32 s62, s47, 65536
    buffer_load_dwordx4 v[112:115], v15, s[12:15], s62 offen nt
    s_waitcnt vmcnt(3)
    s_add_u32 s62, s47, 73728
    buffer_load_dwordx4 v[116:119], v15, s[12:15], s62 offen nt
    s_waitcnt vmcnt(3)
    s_add_u32 s62, s47, 81920
    buffer_load_dwordx4 v[120:123], v15, s[12:15], s62 offen nt
    s_waitcnt vmcnt(3)
    s_add_u32 s62, s47, 90112
    buffer_load_dwordx4 v[124:127], v15, s[12:15], s62 offen nt
    s_waitcnt vmcnt(3)
    s_add_u32 s62, s47, 98304
    buffer_load_dwordx4 v[128:131], v15, s[12:15], s62 offen nt
    s_waitcnt vmcnt(3)
    s_add_u32 s62, s47, 106496
    buffer_load_dwordx4 v[132:135], v15, s[12:15], s62 offen nt
    s_waitcnt vmcnt(3)
    s_add_u32 s62, s47, 114688
    buffer_load_dwordx4 v[136:139], v15, s[12:15], s62 offen nt
    s_waitcnt vmcnt(3)
    s_add_u32 s62, s47, 122880
    buffer_load_dwordx4 v[140:143], v15, s[12:15], s62 offen nt
    s_waitcnt vmcnt(3)
    v_mov_b32 v200, 4628
    v_mov_b32 v201, 1
    s_mov_b64 exec, 1
    ds_add_u32 v200, v201
    s_mov_b64 exec, -1
    s_waitcnt vmcnt(8)
    v_perm_b32 v200, v84, v80, s37
    v_perm_b32 v201, v92, v88, s37
    v_perm_b32 v202, v100, v96, s37
    v_perm_b32 v203, v108, v104, s37
    s_nop 1
    v_mfma_f32_16x16x32_bf16 v[168:171], v[232:235], v[200:203], 0
    v_perm_b32 v204, v84, v80, s38
    v_perm_b32 v205, v92, v88, s38
    v_perm_b32 v206, v100, v96, s38
    v_perm_b32 v207, v108, v104, s38
    s_nop 1
    v_mfma_f32_16x16x32_bf16 v[172:175], v[232:235], v[204:207], 0
    v_perm_b32 v208, v85, v81, s37
    v_perm_b32 v209, v93, v89, s37
    v_perm_b32 v210, v101, v97, s37
    v_perm_b32 v211, v109, v105, s37
    s_nop 1
    v_mfma_f32_16x16x32_bf16 v[176:179], v[232:235], v[208:211], 0
    v_perm_b32 v212, v85, v81, s38
    v_perm_b32 v213, v93, v89, s38
    v_perm_b32 v214, v101, v97, s38
    v_perm_b32 v215, v109, v105, s38
    s_nop 1
    v_mfma_f32_16x16x32_bf16 v[180:183], v[232:235], v[212:215], 0
    v_perm_b32 v200, v86, v82, s37
    v_perm_b32 v201, v94, v90, s37
    v_perm_b32 v202, v102, v98, s37
    v_perm_b32 v203, v110, v106, s37
    s_nop 1
    v_mfma_f32_16x16x32_bf16 v[184:187], v[232:235], v[200:203], 0
    v_perm_b32 v204, v86, v82, s38
    v_perm_b32 v205, v94, v90, s38
    v_perm_b32 v206, v102, v98, s38
    v_perm_b32 v207, v110, v106, s38
    s_nop 1
    v_mfma_f32_16x16x32_bf16 v[188:191], v[232:235], v[204:207], 0
    v_perm_b32 v208, v87, v83, s37
    v_perm_b32 v209, v95, v91, s37
    v_perm_b32 v210, v103, v99, s37
    v_perm_b32 v211, v111, v107, s37
    s_nop 1
    v_mfma_f32_16x16x32_bf16 v[192:195], v[232:235], v[208:211], 0
    v_perm_b32 v212, v87, v83, s38
    v_perm_b32 v213, v95, v91, s38
    v_perm_b32 v214, v103, v99, s38
    v_perm_b32 v215, v111, v107, s38
    s_nop 1
    v_mfma_f32_16x16x32_bf16 v[196:199], v[232:235], v[212:215], 0
    s_cmp_lg_u32 s40, 0
    s_cbranch_scc1 L_noxl2
    v_cmp_eq_u32 vcc, s51, v76
    v_cmp_eq_u32 s[98:99], s36, v77
    s_nop 1
    s_and_b64 vcc, vcc, s[98:99]
    s_nop 1
    s_cmp_eq_u64 vcc, exec
    s_cselect_b32 s50, 1, 0
L_noxl2:
    s_waitcnt vmcnt(6)
    v_perm_b32 v80, v116, v112, s37
    v_perm_b32 v84, v116, v112, s38
    v_perm_b32 v88, v117, v113, s37
    v_perm_b32 v92, v117, v113, s38
    v_perm_b32 v96, v118, v114, s37
    v_perm_b32 v100, v118, v114, s38
    v_perm_b32 v104, v119, v115, s37
    v_perm_b32 v108, v119, v115, s38
    s_waitcnt vmcnt(4)
    v_perm_b32 v81, v124, v120, s37
    v_perm_b32 v85, v124, v120, s38
    v_perm_b32 v89, v125, v121, s37
    v_perm_b32 v93, v125, v121, s38
    v_perm_b32 v97, v126, v122, s37
    v_perm_b32 v101, v126, v122, s38
    v_perm_b32 v105, v127, v123, s37
    v_perm_b32 v109, v127, v123, s38
    s_waitcnt vmcnt(2)
    v_perm_b32 v82, v132, v128, s37
    v_perm_b32 v86, v132, v128, s38
    v_perm_b32 v90, v133, v129, s37
    v_perm_b32 v94, v133, v129, s38
    v_perm_b32 v98, v134, v130, s37
    v_perm_b32 v102, v134, v130, s38
    v_perm_b32 v106, v135, v131, s37
    v_perm_b32 v110, v135, v131, s38
    s_waitcnt vmcnt(0)
    v_perm_b32 v83, v140, v136, s37
    v_perm_b32 v87, v140, v136, s38
    v_perm_b32 v91, v141, v137, s37
    v_perm_b32 v95, v141, v137, s38
    v_perm_b32 v99, v142, v138, s37
    v_perm_b32 v103, v142, v138, s38
    v_perm_b32 v107, v143, v139, s37
    v_perm_b32 v111, v143, v139, s38
    v_mfma_f32_16x16x32_bf16 v[168:171], v[236:239], v[80:83], v[168:171]
    v_mfma_f32_16x16x32_bf16 v[172:175], v[236:239], v[84:87], v[172:175]
    v_mfma_f32_16x16x32_bf16 v[176:179], v[236:239], v[88:91], v[176:179]
    v_mfma_f32_16x16x32_bf16 v[180:183], v[236:239], v[92:95], v[180:183]
    v_mfma_f32_16x16x32_bf16 v[184:187], v[236:239], v[96:99], v[184:187]
    v_mfma_f32_16x16x32_bf16 v[188:191], v[236:239], v[100:103], v[188:191]
    v_mfma_f32_16x16x32_bf16 v[192:195], v[236:239], v[104:107], v[192:195]
    v_mfma_f32_16x16x32_bf16 v[196:199], v[236:239], v[108:111], v[196:199]
    s_lshl_b32 s62, s3, 10
    s_add_u32 s62, s62, 8192
    v_lshl_add_u32 v12, v3, 5, s62
    s_mov_b64 exec, 0xffff
    ds_write2_b32 v12, v168, v169 offset0:0 offset1:128
    ds_write2_b32 v12, v172, v173 offset0:1 offset1:129
    ds_write2_b32 v12, v176, v177 offset0:2 offset1:130
    ds_write2_b32 v12, v180, v181 offset0:3 offset1:131
    ds_write2_b32 v12, v184, v185 offset0:4 offset1:132
    ds_write2_b32 v12, v188, v189 offset0:5 offset1:133
    ds_write2_b32 v12, v192, v193 offset0:6 offset1:134
    ds_write2_b32 v12, v196, v197 offset0:7 offset1:135
    s_mov_b64 exec, -1
    v_mov_b32 v200, 4620
    v_mov_b32 v201, 1
    s_waitcnt lgkmcnt(0)
    s_mov_b64 exec, 1
    ds_add_rtn_u32 v201, v200, v201
    s_waitcnt lgkmcnt(0)
    v_readfirstlane_b32 s62, v201
    s_mov_b64 exec, -1
    s_mov_b32 s69, s62
    s_cmp_lg_u32 s62, 7
    s_cbranch_scc1 L_ap_done
    v_lshrrev_b32 v12, 5, v0
    v_lshlrev_b32 v12, 3, v12
    v_lshlrev_b32 v13, 4, v0
    ds_read_b64 v[200:201], v12 offset:4864
    ds_read_b64 v[202:203], v12 offset:4880
    ds_read_b64 v[204:205], v12 offset:4896
    ds_read_b64 v[206:207], v12 offset:4912
    ds_read_b64 v[208:209], v12 offset:4928
    ds_read_b64 v[210:211], v12 offset:4944
    ds_read_b64 v[212:213], v12 offset:4960
    ds_read_b64 v[214:215], v12 offset:4976
    ds_read_b128 v[80:83], v13 offset:8192
    ds_read_b128 v[84:87], v13 offset:9216
    ds_read_b128 v[88:91], v13 offset:10240
    ds_read_b128 v[92:95], v13 offset:11264
    ds_read_b128 v[96:99], v13 offset:12288
    ds_read_b128 v[100:103], v13 offset:13312
    ds_read_b128 v[104:107], v13 offset:14336
    ds_read_b128 v[108:111], v13 offset:15360
    s_waitcnt lgkmcnt(8)
    v_max3_f32 v12, v200, v202, v204
    v_max3_f32 v12, v12, v206, v208
    v_max3_f32 v12, v12, v210, v212
    v_max_f32 v12, v12, v214
    s_mov_b32 s64, 0x3fb8aa3b
    v_sub_f32 v200, v200, v12
    v_sub_f32 v202, v202, v12
    v_sub_f32 v204, v204, v12
    v_sub_f32 v206, v206, v12
    v_sub_f32 v208, v208, v12
    v_sub_f32 v210, v210, v12
    v_sub_f32 v212, v212, v12
    v_sub_f32 v214, v214, v12
    v_mul_f32 v200, s64, v200
    v_mul_f32 v202, s64, v202
    v_mul_f32 v204, s64, v204
    v_mul_f32 v206, s64, v206
    v_mul_f32 v208, s64, v208
    v_mul_f32 v210, s64, v210
    v_mul_f32 v212, s64, v212
    v_mul_f32 v214, s64, v214
    v_exp_f32 v200, v200
    v_exp_f32 v202, v202
    v_exp_f32 v204, v204
    v_exp_f32 v206, v206
    v_exp_f32 v208, v208
    v_exp_f32 v210, v210
    v_exp_f32 v212, v212
    v_exp_f32 v214, v214
    s_waitcnt lgkmcnt(0)
    v_mul_f32 v216, v200, v80
    v_mul_f32 v217, v200, v81
    v_mul_f32 v218, v200, v82
    v_mul_f32 v219, v200, v83
    v_mul_f32 v220, v200, v201
    v_fmac_f32 v216, v202, v84
    v_fmac_f32 v217, v202, v85
    v_fmac_f32 v218, v202, v86
    v_fmac_f32 v219, v202, v87
    v_fmac_f32 v220, v202, v203
    v_fmac_f32 v216, v204, v88
    v_fmac_f32 v217, v204, v89
    v_fmac_f32 v218, v204, v90
    v_fmac_f32 v219, v204, v91
    v_fmac_f32 v220, v204, v205
    v_fmac_f32 v216, v206, v92
    v_fmac_f32 v217, v206, v93
    v_fmac_f32 v218, v206, v94
    v_fmac_f32 v219, v206, v95
    v_fmac_f32 v220, v206, v207
    v_fmac_f32 v216, v208, v96
    v_fmac_f32 v217, v208, v97
    v_fmac_f32 v218, v208, v98
    v_fmac_f32 v219, v208, v99
    v_fmac_f32 v220, v208, v209
    v_fmac_f32 v216, v210, v100
    v_fmac_f32 v217, v210, v101
    v_fmac_f32 v218, v210, v102
    v_fmac_f32 v219, v210, v103
    v_fmac_f32 v220, v210, v211
    v_fmac_f32 v216, v212, v104
    v_fmac_f32 v217, v212, v105
    v_fmac_f32 v218, v212, v106
    v_fmac_f32 v219, v212, v107
    v_fmac_f32 v220, v212, v213
    v_fmac_f32 v216, v214, v108
    v_fmac_f32 v217, v214, v109
    v_fmac_f32 v218, v214, v110
    v_fmac_f32 v219, v214, v111
    v_fmac_f32 v220, v214, v215
    v_rcp_f32 v221, v220
    v_log_f32 v226, v220
    s_mul_i32 s62, s46, 1024
    s_add_u32 s61, s62, 630784
    s_add_u32 s62, s62, 368640
    v_lshlrev_b32 v13, 4, v0
    v_mul_f32 v216, v216, v221
    v_mul_f32 v217, v217, v221
    v_mul_f32 v218, v218, v221
    v_mul_f32 v219, v219, v221
    v_fma_f32 v226, v12, s64, v226
    v_cvt_pk_bf16_f32 v224, v216, v217
    v_cvt_pk_bf16_f32 v225, v218, v219
    v_mov_b32 v227, s36
    buffer_store_dwordx4 v[224:227], v13, s[28:31], s61 offen
    buffer_store_dwordx4 v[224:227], v13, s[28:31], s62 offen sc1
    v_mov_b32 v12, 4632
    v_mov_b32 v13, 1
    s_mov_b64 exec, 1
    ds_write_b32 v12, v13
    s_mov_b64 exec, -1
    s_branch L_ap_done3
L_ap_done:
L_ap_done3:
    s_cmp_eq_u32 s40, 2
    s_cbranch_scc1 L_L_skip
    s_cmp_lg_u32 s40, 1
    s_cbranch_scc1 L_hone_done
    s_cmp_lg_u32 s69, 0
    s_cbranch_scc1 L_hone_done
    s_sub_u32 s62, s42, 16
    s_mul_i32 s62, s62, 1536
    s_add_u32 s54, s62, 36864
    s_add_u32 s55, s62, 73728
    s_add_u32 s58, s54, 18432
    s_add_u32 s59, s55, 18432
    v_lshlrev_b32 v12, 4, v0
    v_lshrrev_b32 v13, 5, v0
    v_mul_u32_u24 v13, 18432, v13
    v_and_b32 v200, 31, v0
    v_lshl_add_u32 v13, v200, 4, v13
    buffer_load_dwordx4 v[16:19], v12, s[28:31], s54 offen sc1
    buffer_load_dwordx4 v[20:23], v12, s[28:31], s55 offen sc1
    buffer_load_dwordx4 v[24:27], v12, s[28:31], s58 offen sc1
    buffer_load_dwordx4 v[28:31], v12, s[28:31], s59 offen sc1
    buffer_load_dwordx4 v[32:35], v13, s[28:31], s54 offen offset:1024 sc1
    buffer_load_dwordx4 v[36:39], v13, s[28:31], s55 offen offset:1024 sc1
    s_waitcnt vmcnt(0)
    s_mov_b32 s96, 0
L_h1_chk_5:
    v_cmp_eq_u32 vcc, s36, v17
    v_cmp_eq_u32 s[98:99], s36, v19
    s_nop 1
    s_and_b64 vcc, vcc, s[98:99]
    v_cmp_eq_u32 s[98:99], s36, v21
    s_nop 1
    s_and_b64 vcc, vcc, s[98:99]
    v_cmp_eq_u32 s[98:99], s36, v23
    s_nop 1
    s_and_b64 vcc, vcc, s[98:99]
    v_cmp_eq_u32 s[98:99], s36, v25
    s_nop 1
    s_and_b64 vcc, vcc, s[98:99]
    v_cmp_eq_u32 s[98:99], s36, v27
    s_nop 1
    s_and_b64 vcc, vcc, s[98:99]
    v_cmp_eq_u32 s[98:99], s36, v29
    s_nop 1
    s_and_b64 vcc, vcc, s[98:99]
    v_cmp_eq_u32 s[98:99], s36, v31
    s_nop 1
    s_and_b64 vcc, vcc, s[98:99]
    v_cmp_eq_u32 s[98:99], s36, v33
    s_nop 1
    s_and_b64 vcc, vcc, s[98:99]
    v_cmp_eq_u32 s[98:99], s36, v35
    s_nop 1
    s_and_b64 vcc, vcc, s[98:99]
    v_cmp_eq_u32 s[98:99], s36, v37
    s_nop 1
    s_and_b64 vcc, vcc, s[98:99]
    v_cmp_eq_u32 s[98:99], s36, v39
    s_nop 1
    s_and_b64 vcc, vcc, s[98:99]
    s_nop 1
    s_cmp_eq_u64 vcc, exec
    s_cbranch_scc1 L_h1_ok_6
    s_add_u32 s96, s96, 1
    s_cmp_gt_u32 s96, 20000
    s_cbranch_scc1 L_h1_ok_6
    s_sleep 1
    buffer_load_dwordx4 v[16:19], v12, s[28:31], s54 offen sc1
    buffer_load_dwordx4 v[20:23], v12, s[28:31], s55 offen sc1
    buffer_load_dwordx4 v[24:27], v12, s[28:31], s58 offen sc1
    buffer_load_dwordx4 v[28:31], v12, s[28:31], s59 offen sc1
    buffer_load_dwordx4 v[32:35], v13, s[28:31], s54 offen offset:1024 sc1
    buffer_load_dwordx4 v[36:39], v13, s[28:31], s55 offen offset:1024 sc1
    s_waitcnt vmcnt(0)
    s_branch L_h1_chk_5
L_h1_ok_6:
    v_lshlrev_b32 v200, 16, v16
    v_and_b32 v201, 0xffff0000, v16
    v_mul_f32 v202, 0xbfb8aa3b, v200
    v_mul_f32 v203, 0xbfb8aa3b, v201
    v_exp_f32 v202, v202
    v_exp_f32 v203, v203
    v_add_f32 v202, 1.0, v202
    v_add_f32 v203, 1.0, v203
    v_rcp_f32 v204, v202
    v_rcp_f32 v205, v203
    v_mul_f32 v206, v200, v204
    v_mul_f32 v207, v201, v205
    v_cvt_pk_bf16_f32 v206, v206, v207
    v_lshlrev_b32 v200, 16, v206
    v_and_b32 v201, 0xffff0000, v206
    v_lshlrev_b32 v202, 16, v20
    v_and_b32 v203, 0xffff0000, v20
    v_mul_f32 v200, v200, v202
    v_mul_f32 v201, v201, v203
    v_cvt_pk_bf16_f32 v216, v200, v201
    v_lshlrev_b32 v200, 16, v18
    v_and_b32 v201, 0xffff0000, v18
    v_mul_f32 v202, 0xbfb8aa3b, v200
    v_mul_f32 v203, 0xbfb8aa3b, v201
    v_exp_f32 v202, v202
    v_exp_f32 v203, v203
    v_add_f32 v202, 1.0, v202
    v_add_f32 v203, 1.0, v203
    v_rcp_f32 v204, v202
    v_rcp_f32 v205, v203
    v_mul_f32 v206, v200, v204
    v_mul_f32 v207, v201, v205
    v_cvt_pk_bf16_f32 v206, v206, v207
    v_lshlrev_b32 v200, 16, v206
    v_and_b32 v201, 0xffff0000, v206
    v_lshlrev_b32 v202, 16, v22
    v_and_b32 v203, 0xffff0000, v22
    v_mul_f32 v200, v200, v202
    v_mul_f32 v201, v201, v203
    v_cvt_pk_bf16_f32 v217, v200, v201
    v_lshlrev_b32 v200, 16, v24
    v_and_b32 v201, 0xffff0000, v24
    v_mul_f32 v202, 0xbfb8aa3b, v200
    v_mul_f32 v203, 0xbfb8aa3b, v201
    v_exp_f32 v202, v202
    v_exp_f32 v203, v203
    v_add_f32 v202, 1.0, v202
    v_add_f32 v203, 1.0, v203
    v_rcp_f32 v204, v202
    v_rcp_f32 v205, v203
    v_mul_f32 v206, v200, v204
    v_mul_f32 v207, v201, v205
    v_cvt_pk_bf16_f32 v206, v206, v207
    v_lshlrev_b32 v200, 16, v206
    v_and_b32 v201, 0xffff0000, v206
    v_lshlrev_b32 v202, 16, v28
    v_and_b32 v203, 0xffff0000, v28
    v_mul_f32 v200, v200, v202
    v_mul_f32 v201, v201, v203
    v_cvt_pk_bf16_f32 v218, v200, v201
    v_lshlrev_b32 v200, 16, v26
    v_and_b32 v201, 0xffff0000, v26
    v_mul_f32 v202, 0xbfb8aa3b, v200
    v_mul_f32 v203, 0xbfb8aa3b, v201
    v_exp_f32 v202, v202
    v_exp_f32 v203, v203
    v_add_f32 v202, 1.0, v202
    v_add_f32 v203, 1.0, v203
    v_rcp_f32 v204, v202
    v_rcp_f32 v205, v203
    v_mul_f32 v206, v200, v204
    v_mul_f32 v207, v201, v205
    v_cvt_pk_bf16_f32 v206, v206, v207
    v_lshlrev_b32 v200, 16, v206
    v_and_b32 v201, 0xffff0000, v206
    v_lshlrev_b32 v202, 16, v30
    v_and_b32 v203, 0xffff0000, v30
    v_mul_f32 v200, v200, v202
    v_mul_f32 v201, v201, v203
    v_cvt_pk_bf16_f32 v219, v200, v201
    v_lshlrev_b32 v200, 16, v32
    v_and_b32 v201, 0xffff0000, v32
    v_mul_f32 v202, 0xbfb8aa3b, v200
    v_mul_f32 v203, 0xbfb8aa3b, v201
    v_exp_f32 v202, v202
    v_exp_f32 v203, v203
    v_add_f32 v202, 1.0, v202
    v_add_f32 v203, 1.0, v203
    v_rcp_f32 v204, v202
    v_rcp_f32 v205, v203
    v_mul_f32 v206, v200, v204
    v_mul_f32 v207, v201, v205
    v_cvt_pk_bf16_f32 v206, v206, v207
    v_lshlrev_b32 v200, 16, v206
    v_and_b32 v201, 0xffff0000, v206
    v_lshlrev_b32 v202, 16, v36
    v_and_b32 v203, 0xffff0000, v36
    v_mul_f32 v200, v200, v202
    v_mul_f32 v201, v201, v203
    v_cvt_pk_bf16_f32 v220, v200, v201
    v_lshlrev_b32 v200, 16, v34
    v_and_b32 v201, 0xffff0000, v34
    v_mul_f32 v202, 0xbfb8aa3b, v200
    v_mul_f32 v203, 0xbfb8aa3b, v201
    v_exp_f32 v202, v202
    v_exp_f32 v203, v203
    v_add_f32 v202, 1.0, v202
    v_add_f32 v203, 1.0, v203
    v_rcp_f32 v204, v202
    v_rcp_f32 v205, v203
    v_mul_f32 v206, v200, v204
    v_mul_f32 v207, v201, v205
    v_cvt_pk_bf16_f32 v206, v206, v207
    v_lshlrev_b32 v200, 16, v206
    v_and_b32 v201, 0xffff0000, v206
    v_lshlrev_b32 v202, 16, v38
    v_and_b32 v203, 0xffff0000, v38
    v_mul_f32 v200, v200, v202
    v_mul_f32 v201, v201, v203
    v_cvt_pk_bf16_f32 v221, v200, v201
    v_lshlrev_b32 v12, 3, v0
    ds_write_b64 v12, v[216:217] offset:5120
    ds_write_b64 v12, v[218:219] offset:5888
    v_lshrrev_b32 v13, 5, v0
    v_mul_u32_u24 v13, 768, v13
    v_and_b32 v200, 31, v0
    v_lshl_add_u32 v13, v200, 3, v13
    ds_write_b64 v13, v[220:221] offset:5632
    v_mov_b32 v12, 4652
    v_mov_b32 v13, 1
    s_waitcnt lgkmcnt(0)
    s_mov_b64 exec, 1
    ds_write_b32 v12, v13
    s_mov_b64 exec, -1
L_hone_done:
    v_mov_b32 v12, 4628
    s_mov_b32 s96, 0
L_vwait:
    ds_read_b32 v13, v12
    s_waitcnt lgkmcnt(0)
    v_readfirstlane_b32 s62, v13
    s_nop 0
    s_cmp_ge_u32 s62, 8
    s_cbranch_scc1 L_vready
    s_add_u32 s96, s96, 1
    s_cmp_gt_u32 s96, 400000
    s_cbranch_scc1 L_vready
    s_sleep 1
    s_branch L_vwait
L_vready:
    buffer_load_dwordx4 v[144:147], v14, s[20:23], 0 offen offset:0 nt
    buffer_load_dwordx4 v[148:151], v14, s[20:23], 0 offen offset:1152 nt
    buffer_load_dwordx4 v[152:155], v14, s[20:23], 0 offen offset:2304 nt
    buffer_load_dwordx4 v[156:159], v14, s[20:23], 0 offen offset:3456 nt
    buffer_load_dwordx4 v[160:163], v14, s[24:27], s53 offen offset:0 nt
    buffer_load_dwordx4 v[164:167], v14, s[24:27], s53 offen offset:1152 nt
    s_cmp_eq_u32 s40, 1
    s_cbranch_scc1 L_L_down
    v_and_b32 v12, 1, v0
    v_lshlrev_b32 v12, 7, v12
    v_bfe_u32 v13, v0, 2, 2
    v_add_u32 v12, v12, v13
    s_lshl_b32 s62, s42, 3
    v_add_u32 v12, s62, v12
    v_mul_u32_u24 v12, 1024, v12
    s_lshl_b32 s62, s3, 7
    s_add_u32 s56, s62, 368640
    s_mul_i32 s62, s50, 262144
    s_add_u32 s56, s56, s62
    s_add_u32 s57, s56, 4096
    v_bfe_u32 v13, v0, 1, 1
    v_lshl_add_u32 v13, v2, 1, v13
    v_lshl_add_u32 v13, v13, 4, v12
    v_mov_b32 v200, 4632
    s_mov_b32 s96, 0
L_apwait:
    ds_read_b32 v201, v200
    s_waitcnt lgkmcnt(0)
    v_readfirstlane_b32 s62, v201
    s_nop 0
    s_cmp_lg_u32 s62, 0
    s_cbranch_scc1 L_apready
    s_add_u32 s96, s96, 1
    s_cmp_gt_u32 s96, 400000
    s_cbranch_scc1 L_apready
    s_sleep 1
    s_branch L_apwait
L_apready:
    buffer_load_dwordx4 v[16:19], v13, s[28:31], s56 offen sc1
    buffer_load_dwordx4 v[20:23], v13, s[28:31], s57 offen sc1
    s_waitcnt vmcnt(2)
    v_perm_b32 v112, v148, v144, s37
    v_perm_b32 v113, v156, v152, s37
    v_perm_b32 v114, v148, v144, s38
    v_perm_b32 v115, v156, v152, s38
    v_perm_b32 v116, v149, v145, s37
    v_perm_b32 v117, v157, v153, s37
    v_perm_b32 v118, v149, v145, s38
    v_perm_b32 v119, v157, v153, s38
    v_perm_b32 v120, v150, v146, s37
    v_perm_b32 v121, v158, v154, s37
    v_perm_b32 v122, v150, v146, s38
    v_perm_b32 v123, v158, v154, s38
    v_perm_b32 v124, v151, v147, s37
    v_perm_b32 v125, v159, v155, s37
    v_perm_b32 v126, v151, v147, s38
    v_perm_b32 v127, v159, v155, s38
    s_waitcnt vmcnt(0)
    s_mov_b32 s96, 0
L_ap_chk_7:
    v_cmp_ne_u32 vcc, s36, v19
    v_cmp_ne_u32 s[98:99], s36, v23
    s_nop 1
    s_or_b64 vcc, vcc, s[98:99]
    s_nop 1
    s_cmp_eq_u64 vcc, 0
    s_cbranch_scc1 L_ap_ok_8
    s_add_u32 s96, s96, 1
    s_cmp_gt_u32 s96, 20000
    s_cbranch_scc1 L_ap_ok_8
    s_mov_b64 exec, vcc
    buffer_load_dwordx4 v[16:19], v13, s[28:31], s56 offen sc1
    buffer_load_dwordx4 v[20:23], v13, s[28:31], s57 offen sc1
    s_mov_b64 exec, -1
    s_waitcnt vmcnt(0)
    s_branch L_ap_chk_7
L_ap_ok_8:
    v_max_f32 v200, v18, v22
    s_nop 1
    v_max_f32_dpp v200, v200, v200 row_ror:4 row_mask:0xf bank_mask:0xf
    s_nop 1
    v_max_f32_dpp v200, v200, v200 row_ror:8 row_mask:0xf bank_mask:0xf
    v_sub_f32 v18, v18, v200
    v_sub_f32 v22, v22, v200
    v_exp_f32 v18, v18
    v_exp_f32 v22, v22
    v_lshlrev_b32 v201, 16, v16
    v_and_b32 v202, 0xffff0000, v16
    v_lshlrev_b32 v203, 16, v17
    v_and_b32 v204, 0xffff0000, v17
    v_lshlrev_b32 v205, 16, v20
    v_and_b32 v206, 0xffff0000, v20
    v_lshlrev_b32 v207, 16, v21
    v_and_b32 v208, 0xffff0000, v21
    v_add_f32 v200, v18, v22
    v_mul_f32 v201, v18, v201
    v_mul_f32 v202, v18, v202
    v_mul_f32 v203, v18, v203
    v_mul_f32 v204, v18, v204
    v_fmac_f32 v201, v22, v205
    v_fmac_f32 v202, v22, v206
    v_fmac_f32 v203, v22, v207
    v_fmac_f32 v204, v22, v208
    v_add_f32_dpp v200, v200, v200 row_ror:4 row_mask:0xf bank_mask:0xf
    v_add_f32_dpp v201, v201, v201 row_ror:4 row_mask:0xf bank_mask:0xf
    v_add_f32_dpp v202, v202, v202 row_ror:4 row_mask:0xf bank_mask:0xf
    v_add_f32_dpp v203, v203, v203 row_ror:4 row_mask:0xf bank_mask:0xf
    v_add_f32_dpp v204, v204, v204 row_ror:4 row_mask:0xf bank_mask:0xf
    v_add_f32_dpp v200, v200, v200 row_ror:8 row_mask:0xf bank_mask:0xf
    v_add_f32_dpp v201, v201, v201 row_ror:8 row_mask:0xf bank_mask:0xf
    v_add_f32_dpp v202, v202, v202 row_ror:8 row_mask:0xf bank_mask:0xf
    v_add_f32_dpp v203, v203, v203 row_ror:8 row_mask:0xf bank_mask:0xf
    v_add_f32_dpp v204, v204, v204 row_ror:8 row_mask:0xf bank_mask:0xf
    v_rcp_f32 v200, v200
    s_nop 0
    v_mul_f32 v201, v201, v200
    v_mul_f32 v202, v202, v200
    v_mul_f32 v203, v203, v200
    v_mul_f32 v204, v204, v200
    v_cvt_pk_bf16_f32 v6, v201, v202
    v_cvt_pk_bf16_f32 v7, v203, v204
    s_nop 1
    v_mfma_f32_16x16x16_bf16 v[168:171], v[6:7], v[112:113], 0
    v_mfma_f32_16x16x16_bf16 v[172:175], v[6:7], v[114:115], 0
    v_mfma_f32_16x16x16_bf16 v[176:179], v[6:7], v[116:117], 0
    v_mfma_f32_16x16x16_bf16 v[180:183], v[6:7], v[118:119], 0
    v_mfma_f32_16x16x16_bf16 v[184:187], v[6:7], v[120:121], 0
    v_mfma_f32_16x16x16_bf16 v[188:191], v[6:7], v[122:123], 0
    v_mfma_f32_16x16x16_bf16 v[192:195], v[6:7], v[124:125], 0
    v_mfma_f32_16x16x16_bf16 v[196:199], v[6:7], v[126:127], 0
    s_branch L_L_red
L_L_down:
    v_mov_b32 v12, 4652
    s_mov_b32 s96, 0
L_hwait:
    ds_read_b32 v13, v12
    s_waitcnt lgkmcnt(0)
    v_readfirstlane_b32 s62, v13
    s_nop 0
    s_cmp_lg_u32 s62, 0
    s_cbranch_scc1 L_hready
    s_add_u32 s96, s96, 1
    s_cmp_gt_u32 s96, 400000
    s_cbranch_scc1 L_hready
    s_sleep 1
    s_branch L_hwait
L_hready:
    v_and_b32 v12, 1, v0
    v_mul_u32_u24 v12, 768, v12
    v_bfe_u32 v13, v0, 1, 1
    v_lshl_add_u32 v13, v2, 1, v13
    v_mul_u32_u24 v13, 12, v13
    v_add_u32 v12, v12, v13
    s_mul_i32 s62, s3, 96
    v_add_u32 v12, s62, v12
    ds_read_b32 v6, v12 offset:5120
    ds_read_b32 v7, v12 offset:5124
    ds_read_b32 v8, v12 offset:5128
    s_waitcnt lgkmcnt(0)
    v_mov_b32 v9, 0
    s_waitcnt vmcnt(0)
    v_perm_b32 v200, v148, v144, s37
    v_perm_b32 v201, v156, v152, s37
    v_perm_b32 v202, v164, v160, s37
    v_mov_b32 v203, 0
    s_nop 1
    v_mfma_f32_16x16x32_bf16 v[168:171], v[6:9], v[200:203], 0
    v_perm_b32 v204, v148, v144, s38
    v_perm_b32 v205, v156, v152, s38
    v_perm_b32 v206, v164, v160, s38
    v_mov_b32 v207, 0
    s_nop 1
    v_mfma_f32_16x16x32_bf16 v[172:175], v[6:9], v[204:207], 0
    v_perm_b32 v208, v149, v145, s37
    v_perm_b32 v209, v157, v153, s37
    v_perm_b32 v210, v165, v161, s37
    v_mov_b32 v211, 0
    s_nop 1
    v_mfma_f32_16x16x32_bf16 v[176:179], v[6:9], v[208:211], 0
    v_perm_b32 v212, v149, v145, s38
    v_perm_b32 v213, v157, v153, s38
    v_perm_b32 v214, v165, v161, s38
    v_mov_b32 v215, 0
    s_nop 1
    v_mfma_f32_16x16x32_bf16 v[180:183], v[6:9], v[212:215], 0
    v_perm_b32 v200, v150, v146, s37
    v_perm_b32 v201, v158, v154, s37
    v_perm_b32 v202, v166, v162, s37
    v_mov_b32 v203, 0
    s_nop 1
    v_mfma_f32_16x16x32_bf16 v[184:187], v[6:9], v[200:203], 0
    v_perm_b32 v204, v150, v146, s38
    v_perm_b32 v205, v158, v154, s38
    v_perm_b32 v206, v166, v162, s38
    v_mov_b32 v207, 0
    s_nop 1
    v_mfma_f32_16x16x32_bf16 v[188:191], v[6:9], v[204:207], 0
    v_perm_b32 v208, v151, v147, s37
    v_perm_b32 v209, v159, v155, s37
    v_perm_b32 v210, v167, v163, s37
    v_mov_b32 v211, 0
    s_nop 1
    v_mfma_f32_16x16x32_bf16 v[192:195], v[6:9], v[208:211], 0
    v_perm_b32 v212, v151, v147, s38
    v_perm_b32 v213, v159, v155, s38
    v_perm_b32 v214, v167, v163, s38
    v_mov_b32 v215, 0
    s_nop 1
    v_mfma_f32_16x16x32_bf16 v[196:199], v[6:9], v[212:215], 0
L_L_red:
    s_lshl_b32 s62, s3, 9
    v_lshlrev_b32 v12, 5, v5
    v_add_u32 v12, s62, v12
    v_add_f32_dpp v168, v170, v168 row_shl:8 row_mask:0xf bank_mask:0xf
    v_add_f32_dpp v169, v171, v169 row_shl:8 row_mask:0xf bank_mask:0xf
    v_add_f32_dpp v172, v174, v172 row_shl:8 row_mask:0xf bank_mask:0xf
    v_add_f32_dpp v173, v175, v173 row_shl:8 row_mask:0xf bank_mask:0xf
    v_add_f32_dpp v176, v178, v176 row_shl:8 row_mask:0xf bank_mask:0xf
    v_add_f32_dpp v177, v179, v177 row_shl:8 row_mask:0xf bank_mask:0xf
    v_add_f32_dpp v180, v182, v180 row_shl:8 row_mask:0xf bank_mask:0xf
    v_add_f32_dpp v181, v183, v181 row_shl:8 row_mask:0xf bank_mask:0xf
    v_add_f32_dpp v184, v186, v184 row_shl:8 row_mask:0xf bank_mask:0xf
    v_add_f32_dpp v185, v187, v185 row_shl:8 row_mask:0xf bank_mask:0xf
    v_add_f32_dpp v188, v190, v188 row_shl:8 row_mask:0xf bank_mask:0xf
    v_add_f32_dpp v189, v191, v189 row_shl:8 row_mask:0xf bank_mask:0xf
    v_add_f32_dpp v192, v194, v192 row_shl:8 row_mask:0xf bank_mask:0xf
    v_add_f32_dpp v193, v195, v193 row_shl:8 row_mask:0xf bank_mask:0xf
    v_add_f32_dpp v196, v198, v196 row_shl:8 row_mask:0xf bank_mask:0xf
    v_add_f32_dpp v197, v199, v197 row_shl:8 row_mask:0xf bank_mask:0xf
    s_mov_b64 exec, 0xff
    ds_write2_b32 v12, v168, v169 offset0:0 offset1:64
    ds_write2_b32 v12, v172, v173 offset0:1 offset1:65
    ds_write2_b32 v12, v176, v177 offset0:2 offset1:66
    ds_write2_b32 v12, v180, v181 offset0:3 offset1:67
    ds_write2_b32 v12, v184, v185 offset0:4 offset1:68
    ds_write2_b32 v12, v188, v189 offset0:5 offset1:69
    ds_write2_b32 v12, v192, v193 offset0:6 offset1:70
    ds_write2_b32 v12, v196, v197 offset0:7 offset1:71
    s_mov_b64 exec, -1
    s_waitcnt lgkmcnt(0)
    s_barrier
    s_cmp_lg_u32 s3, 1
    s_cbranch_scc1 L_L_skip
    v_lshlrev_b32 v12, 3, v0
    ds_read_b64 v[80:81], v12 offset:0
    ds_read_b64 v[82:83], v12 offset:512
    ds_read_b64 v[84:85], v12 offset:1024
    ds_read_b64 v[86:87], v12 offset:1536
    ds_read_b64 v[88:89], v12 offset:2048
    ds_read_b64 v[90:91], v12 offset:2560
    ds_read_b64 v[92:93], v12 offset:3072
    ds_read_b64 v[94:95], v12 offset:3584
    s_waitcnt lgkmcnt(0)
    v_add_f32 v80, v80, v82
    v_add_f32 v81, v81, v83
    v_add_f32 v80, v80, v84
    v_add_f32 v81, v81, v85
    v_add_f32 v80, v80, v86
    v_add_f32 v81, v81, v87
    v_add_f32 v80, v80, v88
    v_add_f32 v81, v81, v89
    v_add_f32 v80, v80, v90
    v_add_f32 v81, v81, v91
    v_add_f32 v80, v80, v92
    v_add_f32 v81, v81, v93
    v_add_f32 v80, v80, v94
    v_add_f32 v81, v81, v95
    v_mov_b32 v200, v80
    v_mov_b32 v201, s36
    v_mov_b32 v202, v81
    v_mov_b32 v203, s36
    s_mul_i32 s62, s41, 28
    s_add_u32 s62, s62, s42
    s_lshl_b32 s62, s62, 10
    s_add_u32 s62, s62, 110592
    v_lshlrev_b32 v12, 4, v0
    buffer_store_dwordx4 v[200:203], v12, s[28:31], s62 offen sc1
L_L_skip:
    s_cmp_lt_u32 s2, 184
    s_cbranch_scc1 L_fin
    s_cmp_lg_u32 s3, 0
    s_cbranch_scc1 L_fin
    s_and_b32 s62, s2, 7
    s_mul_i32 s62, s62, 9
    s_lshr_b32 s64, s2, 3
    s_add_u32 s62, s62, s64
    s_sub_u32 s62, s62, 23
    s_lshr_b32 s64, s62, 3
    s_and_b32 s65, s62, 7
    s_mul_i32 s66, s64, 28672
    s_lshl_b32 s67, s65, 7
    s_add_u32 s66, s66, s67
    s_add_u32 s66, s66, 110592
    v_lshlrev_b32 v12, 10, v4
    v_lshl_add_u32 v12, v5, 4, v12
    v_cmp_gt_u32 vcc, 32, v0
    v_mov_b32 v13, 0x7fff0000
    v_add_u32 v6, 24576, v12
    v_cndmask_b32 v13, v13, v6, vcc
    s_lshr_b32 s67, s65, 2
    s_mul_i32 s67, s67, 576
    s_lshl_b32 s68, s64, 6
    s_add_u32 s67, s67, s68
    s_and_b32 s68, s65, 3
    s_lshl_b32 s68, s68, 4
    s_add_u32 s67, s67, s68
    s_lshl_b32 s67, s67, 1
    v_lshlrev_b32 v7, 2, v5
    buffer_load_dword v8, v7, s[4:7], s67 offen
    s_add_u32 s68, s66, 8192
    s_add_u32 s69, s66, 16384
    v_cmp_gt_u32 s[54:55], 32, v0
    v_mov_b32 v28, 0
    v_mov_b32 v29, s36
    v_mov_b32 v30, 0
    v_mov_b32 v31, s36
    buffer_load_dwordx4 v[16:19], v12, s[28:31], s66 offen sc1
    buffer_load_dwordx4 v[20:23], v12, s[28:31], s68 offen sc1
    buffer_load_dwordx4 v[24:27], v12, s[28:31], s69 offen sc1
    s_and_b64 exec, exec, s[54:55]
    s_cbranch_execz L_f4a_9
    buffer_load_dwordx4 v[28:31], v13, s[28:31], s66 offen sc1
L_f4a_9:
    s_mov_b64 exec, -1
    s_mov_b64 exec, -1
    s_waitcnt vmcnt(0)
    s_mov_b32 s96, 0
L_fp_chk_11:
    v_cmp_ne_u32 vcc, s36, v17
    v_cmp_ne_u32 s[98:99], s36, v19
    s_nop 1
    s_or_b64 vcc, vcc, s[98:99]
    v_cmp_ne_u32 s[98:99], s36, v21
    s_nop 1
    s_or_b64 vcc, vcc, s[98:99]
    v_cmp_ne_u32 s[98:99], s36, v23
    s_nop 1
    s_or_b64 vcc, vcc, s[98:99]
    v_cmp_ne_u32 s[98:99], s36, v25
    s_nop 1
    s_or_b64 vcc, vcc, s[98:99]
    v_cmp_ne_u32 s[98:99], s36, v27
    s_nop 1
    s_or_b64 vcc, vcc, s[98:99]
    v_cmp_ne_u32 s[98:99], s36, v29
    s_nop 1
    s_or_b64 vcc, vcc, s[98:99]
    v_cmp_ne_u32 s[98:99], s36, v31
    s_nop 1
    s_or_b64 vcc, vcc, s[98:99]
    s_nop 1
    s_cmp_eq_u64 vcc, 0
    s_cbranch_scc1 L_fp_ok_12
    s_add_u32 s96, s96, 1
    s_cmp_gt_u32 s96, 20000
    s_cbranch_scc1 L_fp_ok_12
    s_sleep 2
    s_mov_b64 exec, vcc
    buffer_load_dwordx4 v[16:19], v12, s[28:31], s66 offen sc1
    buffer_load_dwordx4 v[20:23], v12, s[28:31], s68 offen sc1
    buffer_load_dwordx4 v[24:27], v12, s[28:31], s69 offen sc1
    s_and_b64 exec, exec, s[54:55]
    s_cbranch_execz L_f4b_10
    buffer_load_dwordx4 v[28:31], v13, s[28:31], s66 offen sc1
L_f4b_10:
    s_mov_b64 exec, -1
    s_mov_b64 exec, -1
    s_waitcnt vmcnt(0)
    s_branch L_fp_chk_11
L_fp_ok_12:
    v_add_f32 v16, v16, v20
    v_add_f32 v18, v18, v22
    v_add_f32 v24, v24, v28
    v_add_f32 v26, v26, v30
    v_add_f32_dpp v16, v16, v16 row_ror:8 row_mask:0xf bank_mask:0xf
    v_add_f32_dpp v18, v18, v18 row_ror:8 row_mask:0xf bank_mask:0xf
    v_add_f32_dpp v24, v24, v24 row_ror:8 row_mask:0xf bank_mask:0xf
    v_add_f32_dpp v26, v26, v26 row_ror:8 row_mask:0xf bank_mask:0xf
    v_mov_b32 v200, v16
    v_mov_b32 v201, v18
    v_mov_b32 v202, v24
    v_mov_b32 v203, v26
    v_permlane16_swap_b32 v16, v200
    v_permlane16_swap_b32 v18, v201
    v_permlane16_swap_b32 v24, v202
    v_permlane16_swap_b32 v26, v203
    v_add_f32 v16, v16, v200
    v_add_f32 v18, v18, v201
    v_add_f32 v24, v24, v202
    v_add_f32 v26, v26, v203
    v_mov_b32 v200, v16
    v_mov_b32 v201, v18
    v_mov_b32 v202, v24
    v_mov_b32 v203, v26
    v_permlane32_swap_b32 v16, v200
    v_permlane32_swap_b32 v18, v201
    v_permlane32_swap_b32 v24, v202
    v_permlane32_swap_b32 v26, v203
    v_add_f32 v16, v16, v200
    v_add_f32 v18, v18, v201
    v_add_f32 v24, v24, v202
    v_add_f32 v26, v26, v203
    v_cvt_pk_bf16_f32 v200, v16, v18
    v_cvt_pk_bf16_f32 v201, v24, v26
    v_lshlrev_b32 v202, 16, v200
    v_and_b32 v203, 0xffff0000, v200
    v_lshlrev_b32 v204, 16, v8
    v_and_b32 v205, 0xffff0000, v8
    v_add_f32 v202, v202, v204
    v_add_f32 v203, v203, v205
    v_cvt_pk_bf16_f32 v200, v202, v203
    v_lshlrev_b32 v202, 16, v200
    v_and_b32 v203, 0xffff0000, v200
    v_lshlrev_b32 v204, 16, v201
    v_and_b32 v205, 0xffff0000, v201
    v_add_f32 v202, v202, v204
    v_add_f32 v203, v203, v205
    v_cvt_pk_bf16_f32 v200, v202, v203
    s_mov_b64 exec, 0xff
    buffer_store_dword v200, v7, s[32:35], s67 offen
    s_mov_b64 exec, -1
    s_cmp_lg_u32 s2, 184
    s_cbranch_scc1 L_fin
    v_mov_b32 v201, s36
    v_mov_b32 v202, 0
    s_mov_b64 exec, 1
    buffer_store_dword v201, v202, s[28:31], 0 offen
    s_mov_b64 exec, -1
L_fin:
L_end:
    s_endpgm
.section .rodata,"a"
.p2align 6
.amdhsa_kernel parallel_sum__gqa_block_cached__swiglu_ffn__decode_kernel
  .amdhsa_next_free_vgpr 256
  .amdhsa_next_free_sgpr 102
  .amdhsa_accum_offset 256
  .amdhsa_group_segment_fixed_size 0
  .amdhsa_kernarg_size 96
  .amdhsa_user_sgpr_count 2
  .amdhsa_user_sgpr_kernarg_segment_ptr 1
  .amdhsa_system_sgpr_workgroup_id_x 1
.end_amdhsa_kernel
```
